```python
import torch

def _softmax(x, axis=-1):
    return torch.softmax(x, dim=axis)
def _gelu(x):
    return torch.nn.functional.gelu(x, approximate="tanh")
def _silu(x):
    return torch.nn.functional.silu(x)
def _sigmoid(x):
    return torch.sigmoid(x)
def _layernorm(x, axis=-1, eps=1e-5):
    m = x.mean(dim=axis, keepdim=True)
    v = x.var(dim=axis, keepdim=True, unbiased=False)
    return (x - m) / torch.sqrt(v + eps)
def _scatter_add(tgt, idx, src, axis=0):
    return tgt.clone().index_add_(axis, idx, src)
def _segment_sum(src, seg, n):
    out = torch.zeros((n,) + src.shape[1:], dtype=src.dtype)
    return out.index_add_(0, seg, src)
def _pad(x, pw):
    flat = tuple(v for pair in reversed(pw) for v in pair)
    return torch.nn.functional.pad(x, flat)

kernel_name = 'interleave_layers__ssm_conv_s4d__dense_activation_relu__prompt'

def setup_inputs():

    _w = (lambda a: (lambda t: t.to(torch.bfloat16) if t.is_floating_point() else t)(torch.as_tensor(a)))
    def _A_setup():
        Bsz, L, D, N = 1, 2048, 512, 128
        return {
            "u": _w((lambda *s: torch.randn(*s, dtype=torch.bfloat16) * 0.05)(Bsz, L, D)),
            "log_A_real": _w((lambda *s: torch.randn(*s, dtype=torch.bfloat16) * 3.2)(D, N) * 0.5),
            "A_imag": _w((lambda *s: torch.randn(*s, dtype=torch.bfloat16) * 0.2)(D, N) * 3.14),
            "C_real": _w((lambda *s: torch.randn(*s, dtype=torch.bfloat16) * 0.2)(D, N) / N ** 0.5),
            "C_imag": _w((lambda *s: torch.randn(*s, dtype=torch.bfloat16) * 0.2)(D, N) / N ** 0.5),
            "log_dt": _w((lambda *s: torch.randn(*s, dtype=torch.bfloat16) * 0.2)(D) * 0.5 - 4.0),
            "D_skip": _w((lambda *s: torch.randn(*s, dtype=torch.bfloat16) * 0.2)(D)),
        }
    _A_in = _A_setup()

    def _B_setup():
        B, S, D, Dff = 1, 2048, 512, 1792
        return {
            "x": _w((lambda *s: torch.randn(*s, dtype=torch.bfloat16) * 0.05)(B, S, D)),
            "w1": _w((lambda *s: torch.randn(*s, dtype=torch.bfloat16) * 0.05)(D, Dff)),
            "w2": _w((lambda *s: torch.randn(*s, dtype=torch.bfloat16) * 0.05)(Dff, D)),
        }
    _B_in = _B_setup()

    return {
        "A_u": _A_in["u"],
        "A_log_A_real": _A_in["log_A_real"],
        "A_A_imag": _A_in["A_imag"],
        "A_C_real": _A_in["C_real"],
        "A_C_imag": _A_in["C_imag"],
        "A_log_dt": _A_in["log_dt"],
        "A_D_skip": _A_in["D_skip"],
        "B_x": _B_in["x"],
        "B_w1": _B_in["w1"],
        "B_w2": _B_in["w2"],
    }

def reference(A_u, A_log_A_real, A_A_imag, A_C_real, A_C_imag, A_log_dt, A_D_skip, B_x, B_w1, B_w2):
    def _A_ref(u, log_A_real, A_imag, C_real, C_imag, log_dt, D_skip):
        L = u.shape[1]
        dt = torch.exp(log_dt)
        A = -torch.exp(log_A_real) + 1j * A_imag
        C = (C_real + 1j * C_imag) * dt[:, None]
        pos = (lambda x, dt: x.to(dt))(torch.arange(L), log_dt.dtype)
        P = torch.exp((A * dt[:, None])[:, :, None] * pos[None, None, :])
        K = 2.0 * torch.einsum("dn,dnl->dl", C, P).real
        L2 = 2 * L
        u_t = (lambda x, *d: x.permute(*d))(u, 0, 2, 1)
        Kf = (lambda x, *a, **k: torch.fft.rfft(x.float(), *a, **k))(K, L2)
        Uf = (lambda x, *a, **k: torch.fft.rfft(x.float(), *a, **k))(u_t, L2)
        y = (lambda x, *a, **k: torch.fft.irfft(x, *a, **k).to(torch.bfloat16))(Uf * Kf[None, :, :], L2)[:, :, :L]
        y = (lambda x, *d: x.permute(*d))(y, 0, 2, 1)
        return y + u * D_skip[None, None, :]

    def _B_ref(x, w1, w2):
        h = torch.einsum("bsd,df->bsf", x, w1)
        zero = torch.zeros_like(h)
        h = torch.maximum(h, zero)
        return torch.einsum("bsf,fd->bsd", h, w2)

    x = A_u
    x = x + _A_ref(_layernorm(x, axis=-1), A_log_A_real, A_A_imag, A_C_real, A_C_imag, A_log_dt, A_D_skip)
    x = x + _B_ref(_layernorm(x, axis=-1), B_w1, B_w2)
    x = x + _A_ref(_layernorm(x, axis=-1), A_log_A_real, A_A_imag, A_C_real, A_C_imag, A_log_dt, A_D_skip)
    x = x + _B_ref(_layernorm(x, axis=-1), B_w1, B_w2)
    return x
```

```asm
; @launch kernel=prep_kernel grid=(552,1,1) block=(512,1,1) lds=49152
; @launch kernel=conv_kernel grid=(256,1,1) block=(256,1,1) lds=102400
; @launch kernel=g1_kernel grid=(224,1,1) block=(256,1,1) lds=132096
; @launch kernel=g2_kernel grid=(256,1,1) block=(256,1,1) lds=78848
; @launch kernel=conv_kernel grid=(256,1,1) block=(256,1,1) lds=102400
; @launch kernel=g1_kernel grid=(224,1,1) block=(256,1,1) lds=132096
; @launch kernel=g2_kernel grid=(256,1,1) block=(256,1,1) lds=78848
.amdgcn_target "amdgcn-amd-amdhsa--gfx950"
.text
.globl prep_kernel
.p2align 8
.type prep_kernel,@function
prep_kernel:

    s_load_dwordx2 s[12:13], s[0:1], 96
    v_and_b32 v1, 63, v0
    v_lshrrev_b32 v4, 6, v0
    v_and_b32 v2, 15, v0
    v_bfe_u32 v3, v0, 4, 2
    v_readfirstlane_b32 s3, v4
    s_cmp_lt_u32 s2, 256
    s_cbranch_scc1 L_prep_kg
    s_cmp_ge_u32 s3, 4
    s_cbranch_scc1 L_prep_exit
    s_cmp_lt_u32 s2, 384
    s_cbranch_scc1 L_prep_xt
    s_cmp_lt_u32 s2, 440
    s_cbranch_scc1 L_prep_w1
    s_cmp_lt_u32 s2, 552
    s_cbranch_scc1 L_prep_w2
L_prep_exit:
    s_endpgm
L_prep_xt:
    s_load_dwordx2 s[14:15], s[0:1], 0
    s_sub_u32 s16, s2, 256
    s_waitcnt lgkmcnt(0)
    s_mov_b32 s4, s12
    s_and_b32 s5, s13, 0xffff
    s_mov_b32 s6, 0x2000000
    s_mov_b32 s7, 0x00020000
    s_mov_b32 s8, s14
    s_and_b32 s9, s15, 0xffff
    s_mov_b32 s10, 0x200000
    s_mov_b32 s11, 0x00020000
    v_lshrrev_b32 v5, 4, v0
    v_lshlrev_b32 v7, 10, v5
    v_lshl_add_u32 v7, v2, 4, v7
    s_lshl_b32 s19, s16, 14
    buffer_load_dwordx4 v[8:11], v7, s[8:11], s19 offen offset:0
    buffer_load_dwordx4 v[12:15], v7, s[8:11], s19 offen offset:256
    buffer_load_dwordx4 v[16:19], v7, s[8:11], s19 offen offset:512
    buffer_load_dwordx4 v[20:23], v7, s[8:11], s19 offen offset:768
    s_cmp_ge_u32 s16, 1
    s_cbranch_scc1 L_prep_xt_nz
    v_mov_b32 v40, 0
    v_lshlrev_b32 v41, 2, v0
    s_mov_b32 s20, 0x90c000
    buffer_store_dword v40, v41, s[4:7], s20 offen
L_prep_xt_nz:
    s_mov_b32 s21, 0x3f803f80
    v_mov_b32 v30, s21
    v_mul_u32_u24 v31, 1040, v5
    v_lshl_add_u32 v31, v2, 4, v31
    s_waitcnt vmcnt(0)
    ds_write_b128 v31, v[8:11] offset:0
    ds_write_b128 v31, v[12:15] offset:256
    ds_write_b128 v31, v[16:19] offset:512
    ds_write_b128 v31, v[20:23] offset:768
    v_dot2_f32_bf16 v32, v8, v30, 0
    v_dot2_f32_bf16 v33, v8, v8, 0
    v_dot2_f32_bf16 v32, v9, v30, v32
    v_dot2_f32_bf16 v33, v9, v9, v33
    v_dot2_f32_bf16 v32, v10, v30, v32
    v_dot2_f32_bf16 v33, v10, v10, v33
    v_dot2_f32_bf16 v32, v11, v30, v32
    v_dot2_f32_bf16 v33, v11, v11, v33
    v_dot2_f32_bf16 v32, v12, v30, v32
    v_dot2_f32_bf16 v33, v12, v12, v33
    v_dot2_f32_bf16 v32, v13, v30, v32
    v_dot2_f32_bf16 v33, v13, v13, v33
    v_dot2_f32_bf16 v32, v14, v30, v32
    v_dot2_f32_bf16 v33, v14, v14, v33
    v_dot2_f32_bf16 v32, v15, v30, v32
    v_dot2_f32_bf16 v33, v15, v15, v33
    v_dot2_f32_bf16 v32, v16, v30, v32
    v_dot2_f32_bf16 v33, v16, v16, v33
    v_dot2_f32_bf16 v32, v17, v30, v32
    v_dot2_f32_bf16 v33, v17, v17, v33
    v_dot2_f32_bf16 v32, v18, v30, v32
    v_dot2_f32_bf16 v33, v18, v18, v33
    v_dot2_f32_bf16 v32, v19, v30, v32
    v_dot2_f32_bf16 v33, v19, v19, v33
    v_dot2_f32_bf16 v32, v20, v30, v32
    v_dot2_f32_bf16 v33, v20, v20, v33
    v_dot2_f32_bf16 v32, v21, v30, v32
    v_dot2_f32_bf16 v33, v21, v21, v33
    v_dot2_f32_bf16 v32, v22, v30, v32
    v_dot2_f32_bf16 v33, v22, v22, v33
    v_dot2_f32_bf16 v32, v23, v30, v32
    v_dot2_f32_bf16 v33, v23, v23, v33
    s_nop 3
    v_add_f32_dpp v32, v32, v32 quad_perm:[1,0,3,2] row_mask:0xf bank_mask:0xf
    v_add_f32_dpp v33, v33, v33 quad_perm:[1,0,3,2] row_mask:0xf bank_mask:0xf
    s_nop 1
    v_add_f32_dpp v32, v32, v32 quad_perm:[2,3,0,1] row_mask:0xf bank_mask:0xf
    v_add_f32_dpp v33, v33, v33 quad_perm:[2,3,0,1] row_mask:0xf bank_mask:0xf
    s_nop 1
    v_add_f32_dpp v32, v32, v32 row_half_mirror row_mask:0xf bank_mask:0xf
    v_add_f32_dpp v33, v33, v33 row_half_mirror row_mask:0xf bank_mask:0xf
    s_nop 1
    v_add_f32_dpp v32, v32, v32 row_mirror row_mask:0xf bank_mask:0xf
    v_add_f32_dpp v33, v33, v33 row_mirror row_mask:0xf bank_mask:0xf
    s_nop 1
    v_lshlrev_b32 v34, 3, v5
    s_lshl_b32 s19, s16, 7
    s_add_u32 s19, s19, 0x900000
    v_cmp_eq_u32 vcc, 0, v2
    s_and_saveexec_b64 s[22:23], vcc
    buffer_store_dwordx2 v[32:33], v34, s[4:7], s19 offen sc1
    s_mov_b64 exec, s[22:23]
    s_waitcnt lgkmcnt(0)
    s_barrier
    v_lshrrev_b32 v35, 2, v2
    v_mul_u32_u24 v35, 1040, v35
    v_and_b32 v36, 3, v2
    v_lshl_add_u32 v35, v36, 3, v35
    v_lshl_add_u32 v35, v3, 6, v35
    s_lshl_b32 s19, s3, 8
    v_add_u32 v35, s19, v35
    ds_read_b64_tr_b16 v[8:9], v35 offset:0
    ds_read_b64_tr_b16 v[10:11], v35 offset:4160
    ds_read_b64_tr_b16 v[12:13], v35 offset:8320
    ds_read_b64_tr_b16 v[14:15], v35 offset:12480
    ds_read_b64_tr_b16 v[16:17], v35 offset:32
    ds_read_b64_tr_b16 v[18:19], v35 offset:4192
    ds_read_b64_tr_b16 v[20:21], v35 offset:8352
    ds_read_b64_tr_b16 v[22:23], v35 offset:12512
    v_lshl_add_u32 v36, v3, 5, v2
    s_lshl_b32 s19, s3, 7
    v_add_u32 v36, s19, v36
    s_movk_i32 s19, 4352
    v_mul_lo_u32 v36, v36, s19
    v_add_u32 v37, 69632, v36
    s_lshl_b32 s19, s16, 5
    s_add_u32 s19, s19, 0x0
    s_waitcnt lgkmcnt(0)
    buffer_store_dwordx4 v[8:11], v36, s[4:7], s19 offen sc1
    buffer_store_dwordx4 v[12:15], v36, s[4:7], s19 offen offset:16 sc1
    buffer_store_dwordx4 v[16:19], v37, s[4:7], s19 offen sc1
    buffer_store_dwordx4 v[20:23], v37, s[4:7], s19 offen offset:16 sc1
    s_endpgm
L_prep_w1:
    s_load_dwordx2 s[14:15], s[0:1], 64
    s_sub_u32 s16, s2, 384
    s_waitcnt lgkmcnt(0)
    s_mov_b32 s4, s12
    s_and_b32 s5, s13, 0xffff
    s_mov_b32 s6, 0x2000000
    s_mov_b32 s7, 0x00020000
    s_mov_b32 s8, s14
    s_and_b32 s9, s15, 0xffff
    s_mov_b32 s10, 0x1c0000
    s_mov_b32 s11, 0x00020000
    v_lshrrev_b32 v5, 2, v0
    v_and_b32 v6, 3, v0
    s_movk_i32 s17, 3584
    v_mul_lo_u32 v7, v5, s17
    v_lshl_add_u32 v7, v6, 4, v7
    s_lshl_b32 s18, s16, 6
    buffer_load_dwordx4 v[8:11], v7, s[8:11], s18 offen
    s_add_u32 s18, s18, 229376
    buffer_load_dwordx4 v[12:15], v7, s[8:11], s18 offen
    s_add_u32 s18, s18, 229376
    buffer_load_dwordx4 v[16:19], v7, s[8:11], s18 offen
    s_add_u32 s18, s18, 229376
    buffer_load_dwordx4 v[20:23], v7, s[8:11], s18 offen
    s_add_u32 s18, s18, 229376
    buffer_load_dwordx4 v[24:27], v7, s[8:11], s18 offen
    s_add_u32 s18, s18, 229376
    buffer_load_dwordx4 v[28:31], v7, s[8:11], s18 offen
    s_add_u32 s18, s18, 229376
    buffer_load_dwordx4 v[32:35], v7, s[8:11], s18 offen
    s_add_u32 s18, s18, 229376
    buffer_load_dwordx4 v[36:39], v7, s[8:11], s18 offen
    v_mul_u32_u24 v40, 80, v5
    v_lshl_add_u32 v40, v6, 4, v40
    s_waitcnt vmcnt(7)
    ds_write_b128 v40, v[8:11] offset:0
    s_waitcnt vmcnt(6)
    ds_write_b128 v40, v[12:15] offset:5120
    s_waitcnt vmcnt(5)
    ds_write_b128 v40, v[16:19] offset:10240
    s_waitcnt vmcnt(4)
    ds_write_b128 v40, v[20:23] offset:15360
    s_waitcnt vmcnt(3)
    ds_write_b128 v40, v[24:27] offset:20480
    s_waitcnt vmcnt(2)
    ds_write_b128 v40, v[28:31] offset:25600
    s_waitcnt vmcnt(1)
    ds_write_b128 v40, v[32:35] offset:30720
    s_waitcnt vmcnt(0)
    ds_write_b128 v40, v[36:39] offset:35840
    s_waitcnt lgkmcnt(0)
    s_barrier
    v_lshrrev_b32 v41, 2, v2
    v_lshl_add_u32 v41, v3, 2, v41
    v_mul_u32_u24 v41, 80, v41
    v_and_b32 v42, 3, v2
    v_lshl_add_u32 v41, v42, 3, v41
    s_mul_i32 s19, s3, 10240
    v_add_u32 v41, s19, v41
    ds_read_b64_tr_b16 v[8:9], v41 offset:0
    ds_read_b64_tr_b16 v[10:11], v41 offset:1280
    ds_read_b64_tr_b16 v[12:13], v41 offset:32
    ds_read_b64_tr_b16 v[14:15], v41 offset:1312
    ds_read_b64_tr_b16 v[16:17], v41 offset:2560
    ds_read_b64_tr_b16 v[18:19], v41 offset:3840
    ds_read_b64_tr_b16 v[20:21], v41 offset:2592
    ds_read_b64_tr_b16 v[22:23], v41 offset:3872
    ds_read_b64_tr_b16 v[24:25], v41 offset:5120
    ds_read_b64_tr_b16 v[26:27], v41 offset:6400
    ds_read_b64_tr_b16 v[28:29], v41 offset:5152
    ds_read_b64_tr_b16 v[30:31], v41 offset:6432
    ds_read_b64_tr_b16 v[32:33], v41 offset:7680
    ds_read_b64_tr_b16 v[34:35], v41 offset:8960
    ds_read_b64_tr_b16 v[36:37], v41 offset:7712
    ds_read_b64_tr_b16 v[38:39], v41 offset:8992
    s_mov_b32 s21, 0x3f803f80
    v_mov_b32 v43, s21
    v_lshlrev_b32 v44, 4, v1
    s_lshl_b32 s19, s3, 13
    v_add_u32 v44, s19, v44
    s_lshl_b32 s19, s16, 15
    s_add_u32 s19, s19, 0xc00000
    s_add_u32 s20, s19, 4096
    s_waitcnt lgkmcnt(0)
    buffer_store_dwordx4 v[8:11], v44, s[4:7], s19 offen offset:0 sc1
    buffer_store_dwordx4 v[12:15], v44, s[4:7], s19 offen offset:1024 sc1
    buffer_store_dwordx4 v[16:19], v44, s[4:7], s19 offen offset:2048 sc1
    buffer_store_dwordx4 v[20:23], v44, s[4:7], s19 offen offset:3072 sc1
    buffer_store_dwordx4 v[24:27], v44, s[4:7], s20 offen offset:0 sc1
    buffer_store_dwordx4 v[28:31], v44, s[4:7], s20 offen offset:1024 sc1
    buffer_store_dwordx4 v[32:35], v44, s[4:7], s20 offen offset:2048 sc1
    buffer_store_dwordx4 v[36:39], v44, s[4:7], s20 offen offset:3072 sc1
    v_dot2_f32_bf16 v46, v8, v43, 0
    v_dot2_f32_bf16 v46, v9, v43, v46
    v_dot2_f32_bf16 v46, v10, v43, v46
    v_dot2_f32_bf16 v46, v11, v43, v46
    v_dot2_f32_bf16 v46, v16, v43, v46
    v_dot2_f32_bf16 v46, v17, v43, v46
    v_dot2_f32_bf16 v46, v18, v43, v46
    v_dot2_f32_bf16 v46, v19, v43, v46
    v_dot2_f32_bf16 v46, v24, v43, v46
    v_dot2_f32_bf16 v46, v25, v43, v46
    v_dot2_f32_bf16 v46, v26, v43, v46
    v_dot2_f32_bf16 v46, v27, v43, v46
    v_dot2_f32_bf16 v46, v32, v43, v46
    v_dot2_f32_bf16 v46, v33, v43, v46
    v_dot2_f32_bf16 v46, v34, v43, v46
    v_dot2_f32_bf16 v46, v35, v43, v46
    v_dot2_f32_bf16 v47, v12, v43, 0
    v_dot2_f32_bf16 v47, v13, v43, v47
    v_dot2_f32_bf16 v47, v14, v43, v47
    v_dot2_f32_bf16 v47, v15, v43, v47
    v_dot2_f32_bf16 v47, v20, v43, v47
    v_dot2_f32_bf16 v47, v21, v43, v47
    v_dot2_f32_bf16 v47, v22, v43, v47
    v_dot2_f32_bf16 v47, v23, v43, v47
    v_dot2_f32_bf16 v47, v28, v43, v47
    v_dot2_f32_bf16 v47, v29, v43, v47
    v_dot2_f32_bf16 v47, v30, v43, v47
    v_dot2_f32_bf16 v47, v31, v43, v47
    v_dot2_f32_bf16 v47, v36, v43, v47
    v_dot2_f32_bf16 v47, v37, v43, v47
    v_dot2_f32_bf16 v47, v38, v43, v47
    v_dot2_f32_bf16 v47, v39, v43, v47
    s_nop 3
    v_lshlrev_b32 v45, 2, v1
    s_lshl_b32 s19, s3, 9
    v_add_u32 v45, s19, v45
    ds_write_b32 v45, v46 offset:40960
    ds_write_b32 v45, v47 offset:41216
    s_waitcnt lgkmcnt(0)
    s_barrier
    v_cmp_gt_u32 vcc, 32, v0
    s_and_saveexec_b64 s[22:23], vcc
    s_cbranch_execz L_prep_w1_end
    v_bfe_u32 v48, v0, 4, 1
    v_lshlrev_b32 v48, 8, v48
    v_lshl_add_u32 v48, v2, 2, v48
    ds_read_b32 v50, v48 offset:40960
    ds_read_b32 v51, v48 offset:41024
    ds_read_b32 v52, v48 offset:41088
    ds_read_b32 v53, v48 offset:41152
    ds_read_b32 v54, v48 offset:41472
    ds_read_b32 v55, v48 offset:41536
    ds_read_b32 v56, v48 offset:41600
    ds_read_b32 v57, v48 offset:41664
    ds_read_b32 v58, v48 offset:41984
    ds_read_b32 v59, v48 offset:42048
    ds_read_b32 v60, v48 offset:42112
    ds_read_b32 v61, v48 offset:42176
    ds_read_b32 v62, v48 offset:42496
    ds_read_b32 v63, v48 offset:42560
    ds_read_b32 v64, v48 offset:42624
    ds_read_b32 v65, v48 offset:42688
    s_waitcnt lgkmcnt(0)
    v_add_f32 v50, v50, v51
    v_add_f32 v50, v50, v52
    v_add_f32 v50, v50, v53
    v_add_f32 v50, v50, v54
    v_add_f32 v50, v50, v55
    v_add_f32 v50, v50, v56
    v_add_f32 v50, v50, v57
    v_add_f32 v50, v50, v58
    v_add_f32 v50, v50, v59
    v_add_f32 v50, v50, v60
    v_add_f32 v50, v50, v61
    v_add_f32 v50, v50, v62
    v_add_f32 v50, v50, v63
    v_add_f32 v50, v50, v64
    v_add_f32 v50, v50, v65
    v_lshlrev_b32 v49, 2, v0
    s_lshl_b32 s19, s16, 7
    s_add_u32 s19, s19, 0x908000
    buffer_store_dword v50, v49, s[4:7], s19 offen
L_prep_w1_end:
    s_endpgm
L_prep_w2:
    s_load_dwordx2 s[14:15], s[0:1], 72
    s_sub_u32 s16, s2, 440
    s_lshr_b32 s17, s16, 3
    s_and_b32 s18, s16, 7
    s_waitcnt lgkmcnt(0)
    s_mov_b32 s4, s12
    s_and_b32 s5, s13, 0xffff
    s_mov_b32 s6, 0x2000000
    s_mov_b32 s7, 0x00020000
    s_mov_b32 s8, s14
    s_and_b32 s9, s15, 0xffff
    s_mov_b32 s10, 0x1c0000
    s_mov_b32 s11, 0x00020000
    v_lshrrev_b32 v5, 3, v0
    v_and_b32 v6, 7, v0
    v_lshlrev_b32 v7, 10, v5
    v_lshl_add_u32 v7, v6, 4, v7
    s_lshl_b32 s19, s17, 17
    s_lshl_b32 s20, s18, 7
    s_add_u32 s19, s19, s20
    buffer_load_dwordx4 v[8:11], v7, s[8:11], s19 offen
    s_add_u32 s19, s19, 32768
    buffer_load_dwordx4 v[12:15], v7, s[8:11], s19 offen
    s_add_u32 s19, s19, 32768
    buffer_load_dwordx4 v[16:19], v7, s[8:11], s19 offen
    s_add_u32 s19, s19, 32768
    buffer_load_dwordx4 v[20:23], v7, s[8:11], s19 offen
    v_mul_u32_u24 v40, 144, v5
    v_lshl_add_u32 v40, v6, 4, v40
    s_waitcnt vmcnt(3)
    ds_write_b128 v40, v[8:11] offset:0
    s_waitcnt vmcnt(2)
    ds_write_b128 v40, v[12:15] offset:4608
    s_waitcnt vmcnt(1)
    ds_write_b128 v40, v[16:19] offset:9216
    s_waitcnt vmcnt(0)
    ds_write_b128 v40, v[20:23] offset:13824
    s_waitcnt lgkmcnt(0)
    s_barrier
    v_lshrrev_b32 v41, 2, v2
    v_lshl_add_u32 v41, v3, 2, v41
    v_mul_u32_u24 v41, 144, v41
    v_and_b32 v42, 3, v2
    v_lshl_add_u32 v41, v42, 3, v41
    s_mul_i32 s19, s3, 4608
    v_add_u32 v41, s19, v41
    ds_read_b64_tr_b16 v[8:9], v41 offset:0
    ds_read_b64_tr_b16 v[10:11], v41 offset:2304
    ds_read_b64_tr_b16 v[12:13], v41 offset:32
    ds_read_b64_tr_b16 v[14:15], v41 offset:2336
    ds_read_b64_tr_b16 v[16:17], v41 offset:64
    ds_read_b64_tr_b16 v[18:19], v41 offset:2368
    ds_read_b64_tr_b16 v[20:21], v41 offset:96
    ds_read_b64_tr_b16 v[22:23], v41 offset:2400
    v_lshlrev_b32 v44, 4, v1
    s_lshl_b32 s19, s3, 12
    v_add_u32 v44, s19, v44
    s_mul_i32 s19, s18, 56
    s_lshl_b32 s20, s17, 2
    s_add_u32 s19, s19, s20
    s_lshl_b32 s19, s19, 12
    s_add_u32 s19, s19, 0xe00000
    s_waitcnt lgkmcnt(0)
    buffer_store_dwordx4 v[8:11], v44, s[4:7], s19 offen offset:0 sc1
    buffer_store_dwordx4 v[12:15], v44, s[4:7], s19 offen offset:1024 sc1
    buffer_store_dwordx4 v[16:19], v44, s[4:7], s19 offen offset:2048 sc1
    buffer_store_dwordx4 v[20:23], v44, s[4:7], s19 offen offset:3072 sc1
    s_endpgm
L_prep_kg:
    s_load_dwordx4 s[16:19], s[0:1], 8
    s_load_dwordx4 s[20:23], s[0:1], 24
    s_load_dwordx2 s[24:25], s[0:1], 40
    v_and_b32 v5, 255, v0
    v_lshlrev_b32 v5, 1, v5
    s_lshl_b32 s26, s2, 9
    v_bfe_u32 v6, v0, 7, 1
    v_lshlrev_b32 v6, 1, v6
    s_lshl_b32 s27, s2, 2
    s_waitcnt lgkmcnt(0)
    s_mov_b32 s28, s16
    s_and_b32 s29, s17, 0xffff
    s_mov_b32 s30, 0x20000
    s_mov_b32 s31, 0x00020000
    s_mov_b32 s32, s18
    s_and_b32 s33, s19, 0xffff
    s_mov_b32 s34, 0x20000
    s_mov_b32 s35, 0x00020000
    s_mov_b32 s36, s20
    s_and_b32 s37, s21, 0xffff
    s_mov_b32 s38, 0x20000
    s_mov_b32 s39, 0x00020000
    s_mov_b32 s40, s22
    s_and_b32 s41, s23, 0xffff
    s_mov_b32 s42, 0x20000
    s_mov_b32 s43, 0x00020000
    s_mov_b32 s44, s24
    s_and_b32 s45, s25, 0xffff
    s_mov_b32 s46, 0x400
    s_mov_b32 s47, 0x00020000
    buffer_load_ushort v8, v5, s[28:31], s26 offen
    buffer_load_ushort v9, v5, s[32:35], s26 offen
    buffer_load_ushort v10, v5, s[36:39], s26 offen
    buffer_load_ushort v11, v5, s[40:43], s26 offen
    buffer_load_ushort v12, v6, s[44:47], s27 offen
    s_mov_b32 s4, s12
    s_and_b32 s5, s13, 0xffff
    s_mov_b32 s6, 0x2000000
    s_mov_b32 s7, 0x00020000
    v_and_b32 v13, 7, v0
    v_lshrrev_b32 v14, 3, v0
    v_lshl_add_u32 v13, v14, 7, v13
    v_and_b32 v14, 3, v0
    v_lshlrev_b32 v14, 1, v14
    v_subrev_u32 v15, 16, v0
    v_lshrrev_b32 v15, 2, v15
    v_lshl_add_u32 v14, v15, 7, v14
    v_add_u32 v14, 0x100, v14
    v_cmp_le_u32 vcc, 16, v0
    s_nop 1
    v_cndmask_b32 v13, v13, v14, vcc
    v_and_b32 v14, 1, v0
    v_lshlrev_b32 v14, 2, v14
    v_subrev_u32 v15, 24, v0
    v_lshrrev_b32 v15, 1, v15
    v_lshl_add_u32 v14, v15, 7, v14
    v_add_u32 v14, 0x200, v14
    v_cmp_le_u32 vcc, 24, v0
    s_nop 1
    v_cndmask_b32 v13, v13, v14, vcc
    v_subrev_u32 v15, 32, v0
    v_lshlrev_b32 v14, 7, v15
    v_add_u32 v14, 0x400, v14
    v_cmp_le_u32 vcc, 32, v0
    s_nop 1
    v_cndmask_b32 v13, v13, v14, vcc
    v_mov_b32 v14, 0x900
    v_cmp_lt_u32 vcc, 40, v0
    s_nop 1
    v_cndmask_b32 v13, v13, v14, vcc
    v_lshlrev_b32 v14, 2, v0
    v_cmp_gt_u32 vcc, 48, v0
    s_and_saveexec_b64 s[48:49], vcc
    ds_write_b32 v14, v13 offset:4096
    s_mov_b64 exec, s[48:49]
    v_and_b32 v100, 255, v0
    v_lshlrev_b32 v101, 3, v100
    v_sub_u32 v101, 0x7ff, v101
    v_lshrrev_b32 v102, 8, v0
    s_movk_i32 s26, 9728
    v_mul_lo_u32 v103, v102, s26
    v_add_u32 v103, 4352, v103
    v_subrev_u32 v104, 0, v101
    v_cvt_f32_u32 v104, v104
    v_subrev_u32 v105, 1, v101
    v_cvt_f32_u32 v105, v105
    v_subrev_u32 v106, 2, v101
    v_cvt_f32_u32 v106, v106
    v_subrev_u32 v107, 3, v101
    v_cvt_f32_u32 v107, v107
    v_subrev_u32 v108, 4, v101
    v_cvt_f32_u32 v108, v108
    v_subrev_u32 v109, 5, v101
    v_cvt_f32_u32 v109, v109
    v_subrev_u32 v110, 6, v101
    v_cvt_f32_u32 v110, v110
    v_subrev_u32 v111, 7, v101
    v_cvt_f32_u32 v111, v111
    v_cvt_pk_bf16_f32 v104, v104, v104
    v_lshlrev_b32 v104, 16, v104
    v_cvt_pk_bf16_f32 v105, v105, v105
    v_lshlrev_b32 v105, 16, v105
    v_cvt_pk_bf16_f32 v106, v106, v106
    v_lshlrev_b32 v106, 16, v106
    v_cvt_pk_bf16_f32 v107, v107, v107
    v_lshlrev_b32 v107, 16, v107
    v_cvt_pk_bf16_f32 v108, v108, v108
    v_lshlrev_b32 v108, 16, v108
    v_cvt_pk_bf16_f32 v109, v109, v109
    v_lshlrev_b32 v109, 16, v109
    v_cvt_pk_bf16_f32 v110, v110, v110
    v_lshlrev_b32 v110, 16, v110
    v_cvt_pk_bf16_f32 v111, v111, v111
    v_lshlrev_b32 v111, 16, v111
    v_cvt_u32_f32 v104, v104
    v_lshl_add_u32 v104, v104, 2, v103
    v_cvt_u32_f32 v105, v105
    v_lshl_add_u32 v105, v105, 2, v103
    v_cvt_u32_f32 v106, v106
    v_lshl_add_u32 v106, v106, 2, v103
    v_cvt_u32_f32 v107, v107
    v_lshl_add_u32 v107, v107, 2, v103
    v_cvt_u32_f32 v108, v108
    v_lshl_add_u32 v108, v108, 2, v103
    v_cvt_u32_f32 v109, v109
    v_lshl_add_u32 v109, v109, 2, v103
    v_cvt_u32_f32 v110, v110
    v_lshl_add_u32 v110, v110, 2, v103
    v_cvt_u32_f32 v111, v111
    v_lshl_add_u32 v111, v111, 2, v103
    s_mov_b32 s26, 0x3fb8aa3b
    s_mov_b32 s27, 0x3e22f983
    s_waitcnt vmcnt(0)
    v_lshlrev_b32 v8, 16, v8
    v_lshlrev_b32 v9, 16, v9
    v_lshlrev_b32 v10, 16, v10
    v_lshlrev_b32 v11, 16, v11
    v_lshlrev_b32 v12, 16, v12
    v_mul_f32 v12, s26, v12
    v_mul_f32 v8, s26, v8
    v_exp_f32 v12, v12
    v_exp_f32 v8, v8
    s_nop 0
    v_cvt_pk_bf16_f32 v12, v12, v12
    v_lshlrev_b32 v12, 16, v12
    v_cvt_pk_bf16_f32 v8, v8, v8
    v_lshlrev_b32 v8, 16, v8
    v_mul_f32 v8, v8, v12
    v_mul_f32 v9, v9, v12
    v_mul_f32 v10, v10, v12
    v_mul_f32 v11, v11, v12
    v_mul_f32 v16, s26, v8
    v_sub_f32 v16, 0, v16
    v_mul_f32 v17, s27, v9
    v_add_f32 v18, v10, v10
    v_add_f32 v19, v11, v11
    v_lshlrev_b32 v14, 3, v5
    s_cmp_ge_u32 s3, 4
    s_cbranch_scc1 L_prep_kg_np
    ds_write_b128 v14, v[16:19] offset:0
L_prep_kg_np:
    s_waitcnt lgkmcnt(0)
    s_barrier
    v_lshlrev_b32 v14, 2, v2
    ds_read_b32 v20, v14 offset:4096
    ds_read_b32 v21, v14 offset:4160
    ds_read_b32 v22, v14 offset:4224
    v_lshlrev_b32 v23, 3, v2
    v_cvt_f32_u32 v23, v23
    v_lshlrev_b32 v24, 6, v3
    s_lshl_b32 s26, s3, 9
    v_add_u32 v24, s26, v24
    ds_read_b128 v[28:31], v24 offset:0
    v_accvgpr_write_b32 a0, 0
    v_accvgpr_write_b32 a1, 0
    v_accvgpr_write_b32 a2, 0
    v_accvgpr_write_b32 a3, 0
    v_accvgpr_write_b32 a4, 0
    v_accvgpr_write_b32 a5, 0
    v_accvgpr_write_b32 a6, 0
    v_accvgpr_write_b32 a7, 0
    v_accvgpr_write_b32 a8, 0
    v_accvgpr_write_b32 a9, 0
    v_accvgpr_write_b32 a10, 0
    v_accvgpr_write_b32 a11, 0
    v_lshlrev_b32 v14, 4, v3
    ds_read_b128 v[80:83], v14 offset:4096
    ds_read_b128 v[84:87], v14 offset:4160
    ds_read_b128 v[88:91], v14 offset:4224
    s_waitcnt lgkmcnt(4)
    v_cvt_f32_u32 v20, v20
    v_cvt_f32_u32 v21, v21
    v_cvt_f32_u32 v22, v22
    s_waitcnt lgkmcnt(0)
    ds_read_b128 v[32:35], v24 offset:16
    v_mul_f32 v36, v28, v20
    v_mul_f32 v40, v29, v20
    v_mul_f32 v37, v28, v21
    v_mul_f32 v41, v29, v21
    v_mul_f32 v38, v28, v22
    v_mul_f32 v42, v29, v22
    v_mul_f32 v39, v28, v23
    v_mul_f32 v43, v29, v23
    v_exp_f32 v36, v36
    v_fract_f32 v40, v40
    v_exp_f32 v37, v37
    v_fract_f32 v41, v41
    v_exp_f32 v38, v38
    v_fract_f32 v42, v42
    v_exp_f32 v39, v39
    v_fract_f32 v43, v43
    v_sin_f32 v44, v40
    v_cos_f32 v48, v40
    v_sin_f32 v45, v41
    v_cos_f32 v49, v41
    v_sin_f32 v46, v42
    v_cos_f32 v50, v42
    v_sin_f32 v47, v43
    v_cos_f32 v51, v43
    s_nop 0
    v_mul_f32 v44, v36, v44
    v_mul_f32 v48, v36, v48
    v_mul_f32 v45, v37, v45
    v_mul_f32 v49, v37, v49
    v_mul_f32 v46, v38, v46
    v_mul_f32 v50, v38, v50
    v_mul_f32 v47, v39, v47
    v_mul_f32 v51, v39, v51
    v_mul_f32 v52, v31, v44
    v_mul_f32 v56, v31, v48
    v_mul_f32 v53, v31, v45
    v_mul_f32 v57, v31, v49
    v_mul_f32 v54, v31, v46
    v_mul_f32 v58, v31, v50
    v_fma_f32 v52, v30, v48, -v52
    v_fma_f32 v56, -v30, v44, -v56
    v_fma_f32 v53, v30, v49, -v53
    v_fma_f32 v57, -v30, v45, -v57
    v_fma_f32 v54, v30, v50, -v54
    v_fma_f32 v58, -v30, v46, -v58
    v_cvt_pk_bf16_f32 v60, v52, v56
    v_cvt_pk_bf16_f32 v64, v53, v57
    v_cvt_pk_bf16_f32 v68, v54, v58
    v_cvt_pk_bf16_f32 v72, v51, v47
    v_lshlrev_b32 v36, 16, v60
    v_and_b32 v40, 0xffff0000, v60
    v_lshlrev_b32 v37, 16, v64
    v_and_b32 v41, 0xffff0000, v64
    v_lshlrev_b32 v38, 16, v68
    v_and_b32 v42, 0xffff0000, v68
    v_lshlrev_b32 v39, 16, v72
    v_and_b32 v43, 0xffff0000, v72
    v_sub_f32 v36, v52, v36
    v_sub_f32 v40, v56, v40
    v_sub_f32 v37, v53, v37
    v_sub_f32 v41, v57, v41
    v_sub_f32 v38, v54, v38
    v_sub_f32 v42, v58, v42
    v_sub_f32 v39, v51, v39
    v_sub_f32 v43, v47, v43
    v_cvt_pk_bf16_f32 v4, v36, v40
    v_cvt_pk_bf16_f32 v8, v37, v41
    v_cvt_pk_bf16_f32 v12, v38, v42
    v_cvt_pk_bf16_f32 v16, v39, v43
    s_waitcnt lgkmcnt(0)
    ds_read_b128 v[28:31], v24 offset:32
    v_mul_f32 v36, v32, v20
    v_mul_f32 v40, v33, v20
    v_mul_f32 v37, v32, v21
    v_mul_f32 v41, v33, v21
    v_mul_f32 v38, v32, v22
    v_mul_f32 v42, v33, v22
    v_mul_f32 v39, v32, v23
    v_mul_f32 v43, v33, v23
    v_exp_f32 v36, v36
    v_fract_f32 v40, v40
    v_exp_f32 v37, v37
    v_fract_f32 v41, v41
    v_exp_f32 v38, v38
    v_fract_f32 v42, v42
    v_exp_f32 v39, v39
    v_fract_f32 v43, v43
    v_sin_f32 v44, v40
    v_cos_f32 v48, v40
    v_sin_f32 v45, v41
    v_cos_f32 v49, v41
    v_sin_f32 v46, v42
    v_cos_f32 v50, v42
    v_sin_f32 v47, v43
    v_cos_f32 v51, v43
    s_nop 0
    v_mul_f32 v44, v36, v44
    v_mul_f32 v48, v36, v48
    v_mul_f32 v45, v37, v45
    v_mul_f32 v49, v37, v49
    v_mul_f32 v46, v38, v46
    v_mul_f32 v50, v38, v50
    v_mul_f32 v47, v39, v47
    v_mul_f32 v51, v39, v51
    v_mul_f32 v52, v35, v44
    v_mul_f32 v56, v35, v48
    v_mul_f32 v53, v35, v45
    v_mul_f32 v57, v35, v49
    v_mul_f32 v54, v35, v46
    v_mul_f32 v58, v35, v50
    v_fma_f32 v52, v34, v48, -v52
    v_fma_f32 v56, -v34, v44, -v56
    v_fma_f32 v53, v34, v49, -v53
    v_fma_f32 v57, -v34, v45, -v57
    v_fma_f32 v54, v34, v50, -v54
    v_fma_f32 v58, -v34, v46, -v58
    v_cvt_pk_bf16_f32 v61, v52, v56
    v_cvt_pk_bf16_f32 v65, v53, v57
    v_cvt_pk_bf16_f32 v69, v54, v58
    v_cvt_pk_bf16_f32 v73, v51, v47
    v_lshlrev_b32 v36, 16, v61
    v_and_b32 v40, 0xffff0000, v61
    v_lshlrev_b32 v37, 16, v65
    v_and_b32 v41, 0xffff0000, v65
    v_lshlrev_b32 v38, 16, v69
    v_and_b32 v42, 0xffff0000, v69
    v_lshlrev_b32 v39, 16, v73
    v_and_b32 v43, 0xffff0000, v73
    v_sub_f32 v36, v52, v36
    v_sub_f32 v40, v56, v40
    v_sub_f32 v37, v53, v37
    v_sub_f32 v41, v57, v41
    v_sub_f32 v38, v54, v38
    v_sub_f32 v42, v58, v42
    v_sub_f32 v39, v51, v39
    v_sub_f32 v43, v47, v43
    v_cvt_pk_bf16_f32 v5, v36, v40
    v_cvt_pk_bf16_f32 v9, v37, v41
    v_cvt_pk_bf16_f32 v13, v38, v42
    v_cvt_pk_bf16_f32 v17, v39, v43
    s_waitcnt lgkmcnt(0)
    ds_read_b128 v[32:35], v24 offset:48
    v_mul_f32 v36, v28, v20
    v_mul_f32 v40, v29, v20
    v_mul_f32 v37, v28, v21
    v_mul_f32 v41, v29, v21
    v_mul_f32 v38, v28, v22
    v_mul_f32 v42, v29, v22
    v_mul_f32 v39, v28, v23
    v_mul_f32 v43, v29, v23
    v_exp_f32 v36, v36
    v_fract_f32 v40, v40
    v_exp_f32 v37, v37
    v_fract_f32 v41, v41
    v_exp_f32 v38, v38
    v_fract_f32 v42, v42
    v_exp_f32 v39, v39
    v_fract_f32 v43, v43
    v_sin_f32 v44, v40
    v_cos_f32 v48, v40
    v_sin_f32 v45, v41
    v_cos_f32 v49, v41
    v_sin_f32 v46, v42
    v_cos_f32 v50, v42
    v_sin_f32 v47, v43
    v_cos_f32 v51, v43
    s_nop 0
    v_mul_f32 v44, v36, v44
    v_mul_f32 v48, v36, v48
    v_mul_f32 v45, v37, v45
    v_mul_f32 v49, v37, v49
    v_mul_f32 v46, v38, v46
    v_mul_f32 v50, v38, v50
    v_mul_f32 v47, v39, v47
    v_mul_f32 v51, v39, v51
    v_mul_f32 v52, v31, v44
    v_mul_f32 v56, v31, v48
    v_mul_f32 v53, v31, v45
    v_mul_f32 v57, v31, v49
    v_mul_f32 v54, v31, v46
    v_mul_f32 v58, v31, v50
    v_fma_f32 v52, v30, v48, -v52
    v_fma_f32 v56, -v30, v44, -v56
    v_fma_f32 v53, v30, v49, -v53
    v_fma_f32 v57, -v30, v45, -v57
    v_fma_f32 v54, v30, v50, -v54
    v_fma_f32 v58, -v30, v46, -v58
    v_cvt_pk_bf16_f32 v62, v52, v56
    v_cvt_pk_bf16_f32 v66, v53, v57
    v_cvt_pk_bf16_f32 v70, v54, v58
    v_cvt_pk_bf16_f32 v74, v51, v47
    v_lshlrev_b32 v36, 16, v62
    v_and_b32 v40, 0xffff0000, v62
    v_lshlrev_b32 v37, 16, v66
    v_and_b32 v41, 0xffff0000, v66
    v_lshlrev_b32 v38, 16, v70
    v_and_b32 v42, 0xffff0000, v70
    v_lshlrev_b32 v39, 16, v74
    v_and_b32 v43, 0xffff0000, v74
    v_sub_f32 v36, v52, v36
    v_sub_f32 v40, v56, v40
    v_sub_f32 v37, v53, v37
    v_sub_f32 v41, v57, v41
    v_sub_f32 v38, v54, v38
    v_sub_f32 v42, v58, v42
    v_sub_f32 v39, v51, v39
    v_sub_f32 v43, v47, v43
    v_cvt_pk_bf16_f32 v6, v36, v40
    v_cvt_pk_bf16_f32 v10, v37, v41
    v_cvt_pk_bf16_f32 v14, v38, v42
    v_cvt_pk_bf16_f32 v18, v39, v43
    s_waitcnt lgkmcnt(0)
    ds_read_b128 v[28:31], v24 offset:256
    v_mul_f32 v36, v32, v20
    v_mul_f32 v40, v33, v20
    v_mul_f32 v37, v32, v21
    v_mul_f32 v41, v33, v21
    v_mul_f32 v38, v32, v22
    v_mul_f32 v42, v33, v22
    v_mul_f32 v39, v32, v23
    v_mul_f32 v43, v33, v23
    v_exp_f32 v36, v36
    v_fract_f32 v40, v40
    v_exp_f32 v37, v37
    v_fract_f32 v41, v41
    v_exp_f32 v38, v38
    v_fract_f32 v42, v42
    v_exp_f32 v39, v39
    v_fract_f32 v43, v43
    v_sin_f32 v44, v40
    v_cos_f32 v48, v40
    v_sin_f32 v45, v41
    v_cos_f32 v49, v41
    v_sin_f32 v46, v42
    v_cos_f32 v50, v42
    v_sin_f32 v47, v43
    v_cos_f32 v51, v43
    s_nop 0
    v_mul_f32 v44, v36, v44
    v_mul_f32 v48, v36, v48
    v_mul_f32 v45, v37, v45
    v_mul_f32 v49, v37, v49
    v_mul_f32 v46, v38, v46
    v_mul_f32 v50, v38, v50
    v_mul_f32 v47, v39, v47
    v_mul_f32 v51, v39, v51
    v_mul_f32 v52, v35, v44
    v_mul_f32 v56, v35, v48
    v_mul_f32 v53, v35, v45
    v_mul_f32 v57, v35, v49
    v_mul_f32 v54, v35, v46
    v_mul_f32 v58, v35, v50
    v_fma_f32 v52, v34, v48, -v52
    v_fma_f32 v56, -v34, v44, -v56
    v_fma_f32 v53, v34, v49, -v53
    v_fma_f32 v57, -v34, v45, -v57
    v_fma_f32 v54, v34, v50, -v54
    v_fma_f32 v58, -v34, v46, -v58
    v_cvt_pk_bf16_f32 v63, v52, v56
    v_cvt_pk_bf16_f32 v67, v53, v57
    v_cvt_pk_bf16_f32 v71, v54, v58
    v_cvt_pk_bf16_f32 v75, v51, v47
    v_lshlrev_b32 v36, 16, v63
    v_and_b32 v40, 0xffff0000, v63
    v_lshlrev_b32 v37, 16, v67
    v_and_b32 v41, 0xffff0000, v67
    v_lshlrev_b32 v38, 16, v71
    v_and_b32 v42, 0xffff0000, v71
    v_lshlrev_b32 v39, 16, v75
    v_and_b32 v43, 0xffff0000, v75
    v_sub_f32 v36, v52, v36
    v_sub_f32 v40, v56, v40
    v_sub_f32 v37, v53, v37
    v_sub_f32 v41, v57, v41
    v_sub_f32 v38, v54, v38
    v_sub_f32 v42, v58, v42
    v_sub_f32 v39, v51, v39
    v_sub_f32 v43, v47, v43
    v_cvt_pk_bf16_f32 v7, v36, v40
    v_cvt_pk_bf16_f32 v11, v37, v41
    v_cvt_pk_bf16_f32 v15, v38, v42
    v_cvt_pk_bf16_f32 v19, v39, v43
    s_nop 1
    v_mfma_f32_16x16x32_bf16 a[0:3], v[60:63], v[72:75], a[0:3]
    v_mfma_f32_16x16x32_bf16 a[4:7], v[64:67], v[72:75], a[4:7]
    v_mfma_f32_16x16x32_bf16 a[8:11], v[68:71], v[72:75], a[8:11]
    v_mfma_f32_16x16x32_bf16 a[0:3], v[60:63], v[16:19], a[0:3]
    v_mfma_f32_16x16x32_bf16 a[4:7], v[64:67], v[16:19], a[4:7]
    v_mfma_f32_16x16x32_bf16 a[8:11], v[68:71], v[16:19], a[8:11]
    v_mfma_f32_16x16x32_bf16 a[0:3], v[4:7], v[72:75], a[0:3]
    v_mfma_f32_16x16x32_bf16 a[4:7], v[8:11], v[72:75], a[4:7]
    v_mfma_f32_16x16x32_bf16 a[8:11], v[12:15], v[72:75], a[8:11]
    s_waitcnt lgkmcnt(0)
    ds_read_b128 v[32:35], v24 offset:272
    v_mul_f32 v36, v28, v20
    v_mul_f32 v40, v29, v20
    v_mul_f32 v37, v28, v21
    v_mul_f32 v41, v29, v21
    v_mul_f32 v38, v28, v22
    v_mul_f32 v42, v29, v22
    v_mul_f32 v39, v28, v23
    v_mul_f32 v43, v29, v23
    v_exp_f32 v36, v36
    v_fract_f32 v40, v40
    v_exp_f32 v37, v37
    v_fract_f32 v41, v41
    v_exp_f32 v38, v38
    v_fract_f32 v42, v42
    v_exp_f32 v39, v39
    v_fract_f32 v43, v43
    v_sin_f32 v44, v40
    v_cos_f32 v48, v40
    v_sin_f32 v45, v41
    v_cos_f32 v49, v41
    v_sin_f32 v46, v42
    v_cos_f32 v50, v42
    v_sin_f32 v47, v43
    v_cos_f32 v51, v43
    s_nop 0
    v_mul_f32 v44, v36, v44
    v_mul_f32 v48, v36, v48
    v_mul_f32 v45, v37, v45
    v_mul_f32 v49, v37, v49
    v_mul_f32 v46, v38, v46
    v_mul_f32 v50, v38, v50
    v_mul_f32 v47, v39, v47
    v_mul_f32 v51, v39, v51
    v_mul_f32 v52, v31, v44
    v_mul_f32 v56, v31, v48
    v_mul_f32 v53, v31, v45
    v_mul_f32 v57, v31, v49
    v_mul_f32 v54, v31, v46
    v_mul_f32 v58, v31, v50
    v_fma_f32 v52, v30, v48, -v52
    v_fma_f32 v56, -v30, v44, -v56
    v_fma_f32 v53, v30, v49, -v53
    v_fma_f32 v57, -v30, v45, -v57
    v_fma_f32 v54, v30, v50, -v54
    v_fma_f32 v58, -v30, v46, -v58
    v_cvt_pk_bf16_f32 v60, v52, v56
    v_cvt_pk_bf16_f32 v64, v53, v57
    v_cvt_pk_bf16_f32 v68, v54, v58
    v_cvt_pk_bf16_f32 v72, v51, v47
    v_lshlrev_b32 v36, 16, v60
    v_and_b32 v40, 0xffff0000, v60
    v_lshlrev_b32 v37, 16, v64
    v_and_b32 v41, 0xffff0000, v64
    v_lshlrev_b32 v38, 16, v68
    v_and_b32 v42, 0xffff0000, v68
    v_lshlrev_b32 v39, 16, v72
    v_and_b32 v43, 0xffff0000, v72
    v_sub_f32 v36, v52, v36
    v_sub_f32 v40, v56, v40
    v_sub_f32 v37, v53, v37
    v_sub_f32 v41, v57, v41
    v_sub_f32 v38, v54, v38
    v_sub_f32 v42, v58, v42
    v_sub_f32 v39, v51, v39
    v_sub_f32 v43, v47, v43
    v_cvt_pk_bf16_f32 v4, v36, v40
    v_cvt_pk_bf16_f32 v8, v37, v41
    v_cvt_pk_bf16_f32 v12, v38, v42
    v_cvt_pk_bf16_f32 v16, v39, v43
    s_waitcnt lgkmcnt(0)
    ds_read_b128 v[28:31], v24 offset:288
    v_mul_f32 v36, v32, v20
    v_mul_f32 v40, v33, v20
    v_mul_f32 v37, v32, v21
    v_mul_f32 v41, v33, v21
    v_mul_f32 v38, v32, v22
    v_mul_f32 v42, v33, v22
    v_mul_f32 v39, v32, v23
    v_mul_f32 v43, v33, v23
    v_exp_f32 v36, v36
    v_fract_f32 v40, v40
    v_exp_f32 v37, v37
    v_fract_f32 v41, v41
    v_exp_f32 v38, v38
    v_fract_f32 v42, v42
    v_exp_f32 v39, v39
    v_fract_f32 v43, v43
    v_sin_f32 v44, v40
    v_cos_f32 v48, v40
    v_sin_f32 v45, v41
    v_cos_f32 v49, v41
    v_sin_f32 v46, v42
    v_cos_f32 v50, v42
    v_sin_f32 v47, v43
    v_cos_f32 v51, v43
    s_nop 0
    v_mul_f32 v44, v36, v44
    v_mul_f32 v48, v36, v48
    v_mul_f32 v45, v37, v45
    v_mul_f32 v49, v37, v49
    v_mul_f32 v46, v38, v46
    v_mul_f32 v50, v38, v50
    v_mul_f32 v47, v39, v47
    v_mul_f32 v51, v39, v51
    v_mul_f32 v52, v35, v44
    v_mul_f32 v56, v35, v48
    v_mul_f32 v53, v35, v45
    v_mul_f32 v57, v35, v49
    v_mul_f32 v54, v35, v46
    v_mul_f32 v58, v35, v50
    v_fma_f32 v52, v34, v48, -v52
    v_fma_f32 v56, -v34, v44, -v56
    v_fma_f32 v53, v34, v49, -v53
    v_fma_f32 v57, -v34, v45, -v57
    v_fma_f32 v54, v34, v50, -v54
    v_fma_f32 v58, -v34, v46, -v58
    v_cvt_pk_bf16_f32 v61, v52, v56
    v_cvt_pk_bf16_f32 v65, v53, v57
    v_cvt_pk_bf16_f32 v69, v54, v58
    v_cvt_pk_bf16_f32 v73, v51, v47
    v_lshlrev_b32 v36, 16, v61
    v_and_b32 v40, 0xffff0000, v61
    v_lshlrev_b32 v37, 16, v65
    v_and_b32 v41, 0xffff0000, v65
    v_lshlrev_b32 v38, 16, v69
    v_and_b32 v42, 0xffff0000, v69
    v_lshlrev_b32 v39, 16, v73
    v_and_b32 v43, 0xffff0000, v73
    v_sub_f32 v36, v52, v36
    v_sub_f32 v40, v56, v40
    v_sub_f32 v37, v53, v37
    v_sub_f32 v41, v57, v41
    v_sub_f32 v38, v54, v38
    v_sub_f32 v42, v58, v42
    v_sub_f32 v39, v51, v39
    v_sub_f32 v43, v47, v43
    v_cvt_pk_bf16_f32 v5, v36, v40
    v_cvt_pk_bf16_f32 v9, v37, v41
    v_cvt_pk_bf16_f32 v13, v38, v42
    v_cvt_pk_bf16_f32 v17, v39, v43
    s_waitcnt lgkmcnt(0)
    ds_read_b128 v[32:35], v24 offset:304
    v_mul_f32 v36, v28, v20
    v_mul_f32 v40, v29, v20
    v_mul_f32 v37, v28, v21
    v_mul_f32 v41, v29, v21
    v_mul_f32 v38, v28, v22
    v_mul_f32 v42, v29, v22
    v_mul_f32 v39, v28, v23
    v_mul_f32 v43, v29, v23
    v_exp_f32 v36, v36
    v_fract_f32 v40, v40
    v_exp_f32 v37, v37
    v_fract_f32 v41, v41
    v_exp_f32 v38, v38
    v_fract_f32 v42, v42
    v_exp_f32 v39, v39
    v_fract_f32 v43, v43
    v_sin_f32 v44, v40
    v_cos_f32 v48, v40
    v_sin_f32 v45, v41
    v_cos_f32 v49, v41
    v_sin_f32 v46, v42
    v_cos_f32 v50, v42
    v_sin_f32 v47, v43
    v_cos_f32 v51, v43
    s_nop 0
    v_mul_f32 v44, v36, v44
    v_mul_f32 v48, v36, v48
    v_mul_f32 v45, v37, v45
    v_mul_f32 v49, v37, v49
    v_mul_f32 v46, v38, v46
    v_mul_f32 v50, v38, v50
    v_mul_f32 v47, v39, v47
    v_mul_f32 v51, v39, v51
    v_mul_f32 v52, v31, v44
    v_mul_f32 v56, v31, v48
    v_mul_f32 v53, v31, v45
    v_mul_f32 v57, v31, v49
    v_mul_f32 v54, v31, v46
    v_mul_f32 v58, v31, v50
    v_fma_f32 v52, v30, v48, -v52
    v_fma_f32 v56, -v30, v44, -v56
    v_fma_f32 v53, v30, v49, -v53
    v_fma_f32 v57, -v30, v45, -v57
    v_fma_f32 v54, v30, v50, -v54
    v_fma_f32 v58, -v30, v46, -v58
    v_cvt_pk_bf16_f32 v62, v52, v56
    v_cvt_pk_bf16_f32 v66, v53, v57
    v_cvt_pk_bf16_f32 v70, v54, v58
    v_cvt_pk_bf16_f32 v74, v51, v47
    v_lshlrev_b32 v36, 16, v62
    v_and_b32 v40, 0xffff0000, v62
    v_lshlrev_b32 v37, 16, v66
    v_and_b32 v41, 0xffff0000, v66
    v_lshlrev_b32 v38, 16, v70
    v_and_b32 v42, 0xffff0000, v70
    v_lshlrev_b32 v39, 16, v74
    v_and_b32 v43, 0xffff0000, v74
    v_sub_f32 v36, v52, v36
    v_sub_f32 v40, v56, v40
    v_sub_f32 v37, v53, v37
    v_sub_f32 v41, v57, v41
    v_sub_f32 v38, v54, v38
    v_sub_f32 v42, v58, v42
    v_sub_f32 v39, v51, v39
    v_sub_f32 v43, v47, v43
    v_cvt_pk_bf16_f32 v6, v36, v40
    v_cvt_pk_bf16_f32 v10, v37, v41
    v_cvt_pk_bf16_f32 v14, v38, v42
    v_cvt_pk_bf16_f32 v18, v39, v43
    s_waitcnt lgkmcnt(0)
    v_mul_f32 v36, v32, v20
    v_mul_f32 v40, v33, v20
    v_mul_f32 v37, v32, v21
    v_mul_f32 v41, v33, v21
    v_mul_f32 v38, v32, v22
    v_mul_f32 v42, v33, v22
    v_mul_f32 v39, v32, v23
    v_mul_f32 v43, v33, v23
    v_exp_f32 v36, v36
    v_fract_f32 v40, v40
    v_exp_f32 v37, v37
    v_fract_f32 v41, v41
    v_exp_f32 v38, v38
    v_fract_f32 v42, v42
    v_exp_f32 v39, v39
    v_fract_f32 v43, v43
    v_sin_f32 v44, v40
    v_cos_f32 v48, v40
    v_sin_f32 v45, v41
    v_cos_f32 v49, v41
    v_sin_f32 v46, v42
    v_cos_f32 v50, v42
    v_sin_f32 v47, v43
    v_cos_f32 v51, v43
    s_nop 0
    v_mul_f32 v44, v36, v44
    v_mul_f32 v48, v36, v48
    v_mul_f32 v45, v37, v45
    v_mul_f32 v49, v37, v49
    v_mul_f32 v46, v38, v46
    v_mul_f32 v50, v38, v50
    v_mul_f32 v47, v39, v47
    v_mul_f32 v51, v39, v51
    v_mul_f32 v52, v35, v44
    v_mul_f32 v56, v35, v48
    v_mul_f32 v53, v35, v45
    v_mul_f32 v57, v35, v49
    v_mul_f32 v54, v35, v46
    v_mul_f32 v58, v35, v50
    v_fma_f32 v52, v34, v48, -v52
    v_fma_f32 v56, -v34, v44, -v56
    v_fma_f32 v53, v34, v49, -v53
    v_fma_f32 v57, -v34, v45, -v57
    v_fma_f32 v54, v34, v50, -v54
    v_fma_f32 v58, -v34, v46, -v58
    v_cvt_pk_bf16_f32 v63, v52, v56
    v_cvt_pk_bf16_f32 v67, v53, v57
    v_cvt_pk_bf16_f32 v71, v54, v58
    v_cvt_pk_bf16_f32 v75, v51, v47
    v_lshlrev_b32 v36, 16, v63
    v_and_b32 v40, 0xffff0000, v63
    v_lshlrev_b32 v37, 16, v67
    v_and_b32 v41, 0xffff0000, v67
    v_lshlrev_b32 v38, 16, v71
    v_and_b32 v42, 0xffff0000, v71
    v_lshlrev_b32 v39, 16, v75
    v_and_b32 v43, 0xffff0000, v75
    v_sub_f32 v36, v52, v36
    v_sub_f32 v40, v56, v40
    v_sub_f32 v37, v53, v37
    v_sub_f32 v41, v57, v41
    v_sub_f32 v38, v54, v38
    v_sub_f32 v42, v58, v42
    v_sub_f32 v39, v51, v39
    v_sub_f32 v43, v47, v43
    v_cvt_pk_bf16_f32 v7, v36, v40
    v_cvt_pk_bf16_f32 v11, v37, v41
    v_cvt_pk_bf16_f32 v15, v38, v42
    v_cvt_pk_bf16_f32 v19, v39, v43
    s_nop 1
    v_mfma_f32_16x16x32_bf16 a[0:3], v[60:63], v[72:75], a[0:3]
    v_mfma_f32_16x16x32_bf16 a[4:7], v[64:67], v[72:75], a[4:7]
    v_mfma_f32_16x16x32_bf16 a[8:11], v[68:71], v[72:75], a[8:11]
    v_mfma_f32_16x16x32_bf16 a[0:3], v[60:63], v[16:19], a[0:3]
    v_mfma_f32_16x16x32_bf16 a[4:7], v[64:67], v[16:19], a[4:7]
    v_mfma_f32_16x16x32_bf16 a[8:11], v[68:71], v[16:19], a[8:11]
    v_mfma_f32_16x16x32_bf16 a[0:3], v[4:7], v[72:75], a[0:3]
    v_mfma_f32_16x16x32_bf16 a[4:7], v[8:11], v[72:75], a[4:7]
    v_mfma_f32_16x16x32_bf16 a[8:11], v[12:15], v[72:75], a[8:11]
    v_lshlrev_b32 v15, 5, v2
    s_lshr_b32 s26, s3, 2
    s_mul_i32 s26, s26, 9728
    s_add_u32 s26, s26, 4352
    v_add_u32 v15, s26, v15
    v_lshl_add_u32 v80, v80, 2, v15
    v_lshl_add_u32 v81, v81, 2, v15
    v_lshl_add_u32 v82, v82, 2, v15
    v_lshl_add_u32 v83, v83, 2, v15
    v_lshl_add_u32 v84, v84, 2, v15
    v_lshl_add_u32 v85, v85, 2, v15
    v_lshl_add_u32 v86, v86, 2, v15
    v_lshl_add_u32 v87, v87, 2, v15
    v_lshl_add_u32 v88, v88, 2, v15
    v_lshl_add_u32 v89, v89, 2, v15
    v_lshl_add_u32 v90, v90, 2, v15
    v_lshl_add_u32 v91, v91, 2, v15
    v_lshlrev_b32 v16, 4, v1
    s_mul_i32 s26, s3, 3072
    v_add_u32 v16, s26, v16
    s_and_b32 s27, s3, 3
    s_cmp_eq_u32 s27, 0
    s_cbranch_scc1 L_prep_kg_a
    ds_write_b128 v16, a[0:3] offset:23808
    ds_write_b128 v16, a[4:7] offset:24832
    ds_write_b128 v16, a[8:11] offset:25856
    s_waitcnt lgkmcnt(0)
    s_barrier
    s_barrier
    s_branch L_prep_kg_b
L_prep_kg_a:
    v_accvgpr_read_b32 v64, a0
    v_accvgpr_read_b32 v65, a1
    v_accvgpr_read_b32 v66, a2
    v_accvgpr_read_b32 v67, a3
    v_accvgpr_read_b32 v68, a4
    v_accvgpr_read_b32 v69, a5
    v_accvgpr_read_b32 v70, a6
    v_accvgpr_read_b32 v71, a7
    v_accvgpr_read_b32 v72, a8
    v_accvgpr_read_b32 v73, a9
    v_accvgpr_read_b32 v74, a10
    v_accvgpr_read_b32 v75, a11
    s_barrier
    ds_read_b128 v[20:23], v16 offset:26880
    ds_read_b128 v[24:27], v16 offset:27904
    ds_read_b128 v[28:31], v16 offset:28928
    ds_read_b128 v[32:35], v16 offset:29952
    ds_read_b128 v[36:39], v16 offset:30976
    ds_read_b128 v[40:43], v16 offset:32000
    ds_read_b128 v[44:47], v16 offset:33024
    ds_read_b128 v[48:51], v16 offset:34048
    ds_read_b128 v[52:55], v16 offset:35072
    s_waitcnt lgkmcnt(0)
    v_add_f32 v64, v64, v20
    v_add_f32 v32, v32, v44
    v_add_f32 v65, v65, v21
    v_add_f32 v33, v33, v45
    v_add_f32 v66, v66, v22
    v_add_f32 v34, v34, v46
    v_add_f32 v67, v67, v23
    v_add_f32 v35, v35, v47
    v_add_f32 v68, v68, v24
    v_add_f32 v36, v36, v48
    v_add_f32 v69, v69, v25
    v_add_f32 v37, v37, v49
    v_add_f32 v70, v70, v26
    v_add_f32 v38, v38, v50
    v_add_f32 v71, v71, v27
    v_add_f32 v39, v39, v51
    v_add_f32 v72, v72, v28
    v_add_f32 v40, v40, v52
    v_add_f32 v73, v73, v29
    v_add_f32 v41, v41, v53
    v_add_f32 v74, v74, v30
    v_add_f32 v42, v42, v54
    v_add_f32 v75, v75, v31
    v_add_f32 v43, v43, v55
    v_add_f32 v64, v64, v32
    v_add_f32 v65, v65, v33
    v_add_f32 v66, v66, v34
    v_add_f32 v67, v67, v35
    v_add_f32 v68, v68, v36
    v_add_f32 v69, v69, v37
    v_add_f32 v70, v70, v38
    v_add_f32 v71, v71, v39
    v_add_f32 v72, v72, v40
    v_add_f32 v73, v73, v41
    v_add_f32 v74, v74, v42
    v_add_f32 v75, v75, v43
    ds_write_b32 v80, v64
    ds_write_b32 v81, v65
    ds_write_b32 v82, v66
    ds_write_b32 v83, v67
    ds_write_b32 v84, v68
    ds_write_b32 v85, v69
    ds_write_b32 v86, v70
    ds_write_b32 v87, v71
    ds_write_b32 v88, v72
    ds_write_b32 v89, v73
    ds_write_b32 v90, v74
    ds_write_b32 v91, v75
    s_waitcnt lgkmcnt(0)
    s_barrier
L_prep_kg_b:
    s_cmp_ge_u32 s3, 8
    s_cbranch_scc1 L_prep_kg_end
    ds_read_b32 v32, v104
    ds_read_b32 v33, v105
    ds_read_b32 v34, v106
    ds_read_b32 v35, v107
    ds_read_b32 v36, v108
    ds_read_b32 v37, v109
    ds_read_b32 v38, v110
    ds_read_b32 v39, v111
    s_movk_i32 s26, 4224
    v_mul_lo_u32 v7, v102, s26
    v_lshl_add_u32 v8, v100, 4, v7
    s_mul_i32 s26, s2, 8448
    s_add_u32 s26, s26, 0x980000
    v_mov_b32 v56, 0
    v_mov_b32 v57, 0
    v_mov_b32 v58, 0
    v_mov_b32 v59, 0
    s_waitcnt lgkmcnt(0)
    v_cvt_pk_bf16_f32 v48, v32, v33
    v_cvt_pk_bf16_f32 v49, v34, v35
    v_cvt_pk_bf16_f32 v50, v36, v37
    v_cvt_pk_bf16_f32 v51, v38, v39
    buffer_store_dwordx4 v[48:51], v8, s[4:7], s26 offen sc1
    v_cmp_gt_u32 vcc, 8, v100
    s_and_saveexec_b64 s[48:49], vcc
    s_cbranch_execz L_prep_kg_end
    s_add_u32 s26, s26, 4096
    buffer_store_dwordx4 v[56:59], v8, s[4:7], s26 offen sc1
L_prep_kg_end:
    s_endpgm

.globl conv_kernel
.p2align 8
.type conv_kernel,@function
conv_kernel:

    s_cmp_ge_u32 s2, 256
    s_cbranch_scc1 L_conv_kernel_end
    s_load_dwordx2 s[12:13], s[0:1], 96
    s_load_dwordx2 s[14:15], s[0:1], 48
    v_and_b32 v1, 63, v0
    v_lshrrev_b32 v4, 6, v0
    v_and_b32 v2, 15, v0
    v_bfe_u32 v3, v0, 4, 2
    v_readfirstlane_b32 s3, v4
    s_waitcnt lgkmcnt(0)
    s_mov_b32 s4, s12
    s_and_b32 s5, s13, 0xffff
    s_mov_b32 s6, 0x2000000
    s_mov_b32 s7, 0x00020000
    s_mov_b32 s8, s14
    s_and_b32 s9, s15, 0xffff
    s_mov_b32 s10, 0x400
    s_mov_b32 s11, 0x00020000
    v_lshlrev_b32 v5, 6, v0
    v_lshlrev_b32 v6, 4, v0
    s_mov_b32 s16, 0x900000
    buffer_load_dwordx4 v[64:67], v5, s[4:7], s16 offen offset:0
    buffer_load_dwordx4 v[68:71], v5, s[4:7], s16 offen offset:16
    buffer_load_dwordx4 v[72:75], v5, s[4:7], s16 offen offset:32
    buffer_load_dwordx4 v[76:79], v5, s[4:7], s16 offen offset:48
    s_mul_i32 s17, s2, 8704
    s_add_u32 s18, s17, 0x0
    s_add_u32 s19, s18, 4352
    buffer_load_dwordx4 v[32:35], v6, s[4:7], s18 offen
    buffer_load_dwordx4 v[36:39], v6, s[4:7], s19 offen
    s_mul_i32 s20, s2, 8448
    s_add_u32 s20, s20, 0x980000
    s_add_u32 s21, s20, 4224
    buffer_load_dwordx4 v[40:43], v6, s[4:7], s20 offen
    buffer_load_dwordx4 v[44:47], v6, s[4:7], s20 offen offset:16
    buffer_load_dwordx4 v[48:51], v6, s[4:7], s21 offen
    buffer_load_dwordx4 v[52:55], v6, s[4:7], s21 offen offset:16
    s_lshl_b32 s22, s2, 2
    v_mov_b32 v8, 0
    buffer_load_dword v56, v8, s[8:11], s22 offen
    v_mov_b32 v12, 0
    v_mov_b32 v13, 0
    v_mov_b32 v14, 0
    v_mov_b32 v15, 0
    v_mul_u32_u24 v7, 4256, v0
    v_cmp_gt_u32 vcc, 32, v0
    s_and_saveexec_b64 s[24:25], vcc
    ds_write_b128 v6, v[12:15] offset:512
    ds_write_b128 v6, v[12:15] offset:5120
    v_cmp_gt_u32 vcc, 16, v0
    s_and_b64 exec, exec, vcc
    ds_write_b128 v7, v[12:15] offset:38400
    s_mov_b64 exec, s[24:25]
    s_waitcnt vmcnt(7)
    v_mul_f32 v64, 0x3b000000, v64
    v_mul_f32 v65, 0x3b000000, v65
    v_mul_f32 v66, 0x3b000000, v66
    v_mul_f32 v67, 0x3b000000, v67
    v_mul_f32 v68, 0x3b000000, v68
    v_mul_f32 v69, 0x3b000000, v69
    v_mul_f32 v70, 0x3b000000, v70
    v_mul_f32 v71, 0x3b000000, v71
    v_mul_f32 v72, 0x3b000000, v72
    v_mul_f32 v73, 0x3b000000, v73
    v_mul_f32 v74, 0x3b000000, v74
    v_mul_f32 v75, 0x3b000000, v75
    v_mul_f32 v76, 0x3b000000, v76
    v_mul_f32 v77, 0x3b000000, v77
    v_mul_f32 v78, 0x3b000000, v78
    v_mul_f32 v79, 0x3b000000, v79
    v_fma_f32 v65, -v64, v64, v65
    v_fma_f32 v67, -v66, v66, v67
    v_fma_f32 v69, -v68, v68, v69
    v_fma_f32 v71, -v70, v70, v71
    v_fma_f32 v73, -v72, v72, v73
    v_fma_f32 v75, -v74, v74, v75
    v_fma_f32 v77, -v76, v76, v77
    v_fma_f32 v79, -v78, v78, v79
    v_max_f32 v65, 0, v65
    v_max_f32 v67, 0, v67
    v_max_f32 v69, 0, v69
    v_max_f32 v71, 0, v71
    v_max_f32 v73, 0, v73
    v_max_f32 v75, 0, v75
    v_max_f32 v77, 0, v77
    v_max_f32 v79, 0, v79
    v_cvt_pk_bf16_f32 v65, v65, v64
    v_cvt_pk_bf16_f32 v67, v67, v66
    v_cvt_pk_bf16_f32 v69, v69, v68
    v_cvt_pk_bf16_f32 v71, v71, v70
    v_cvt_pk_bf16_f32 v73, v73, v72
    v_cvt_pk_bf16_f32 v75, v75, v74
    v_cvt_pk_bf16_f32 v77, v77, v76
    v_cvt_pk_bf16_f32 v79, v79, v78
    v_and_b32 v200, 0xffff0000, v65
    v_lshlrev_b32 v65, 16, v65
    v_and_b32 v201, 0xffff0000, v67
    v_lshlrev_b32 v67, 16, v67
    v_and_b32 v202, 0xffff0000, v69
    v_lshlrev_b32 v69, 16, v69
    v_and_b32 v203, 0xffff0000, v71
    v_lshlrev_b32 v71, 16, v71
    v_and_b32 v204, 0xffff0000, v73
    v_lshlrev_b32 v73, 16, v73
    v_and_b32 v205, 0xffff0000, v75
    v_lshlrev_b32 v75, 16, v75
    v_and_b32 v206, 0xffff0000, v77
    v_lshlrev_b32 v77, 16, v77
    v_and_b32 v207, 0xffff0000, v79
    v_lshlrev_b32 v79, 16, v79
    v_add_f32 v65, 0x3727c5ac, v65
    v_add_f32 v67, 0x3727c5ac, v67
    v_add_f32 v69, 0x3727c5ac, v69
    v_add_f32 v71, 0x3727c5ac, v71
    v_add_f32 v73, 0x3727c5ac, v73
    v_add_f32 v75, 0x3727c5ac, v75
    v_add_f32 v77, 0x3727c5ac, v77
    v_add_f32 v79, 0x3727c5ac, v79
    v_cvt_pk_bf16_f32 v65, v65, v65
    v_cvt_pk_bf16_f32 v67, v67, v67
    v_cvt_pk_bf16_f32 v69, v69, v69
    v_cvt_pk_bf16_f32 v71, v71, v71
    v_cvt_pk_bf16_f32 v73, v73, v73
    v_cvt_pk_bf16_f32 v75, v75, v75
    v_cvt_pk_bf16_f32 v77, v77, v77
    v_cvt_pk_bf16_f32 v79, v79, v79
    v_lshlrev_b32 v65, 16, v65
    v_lshlrev_b32 v67, 16, v67
    v_lshlrev_b32 v69, 16, v69
    v_lshlrev_b32 v71, 16, v71
    v_lshlrev_b32 v73, 16, v73
    v_lshlrev_b32 v75, 16, v75
    v_lshlrev_b32 v77, 16, v77
    v_lshlrev_b32 v79, 16, v79
    v_sqrt_f32 v65, v65
    v_sqrt_f32 v67, v67
    v_sqrt_f32 v69, v69
    v_sqrt_f32 v71, v71
    v_sqrt_f32 v73, v73
    v_sqrt_f32 v75, v75
    v_sqrt_f32 v77, v77
    v_sqrt_f32 v79, v79
    s_nop 0
    v_cvt_pk_bf16_f32 v216, v65, v65
    v_cvt_pk_bf16_f32 v217, v67, v67
    v_cvt_pk_bf16_f32 v218, v69, v69
    v_cvt_pk_bf16_f32 v219, v71, v71
    v_cvt_pk_bf16_f32 v220, v73, v73
    v_cvt_pk_bf16_f32 v221, v75, v75
    v_cvt_pk_bf16_f32 v222, v77, v77
    v_cvt_pk_bf16_f32 v223, v79, v79
    v_lshlrev_b32 v216, 16, v216
    v_lshlrev_b32 v217, 16, v217
    v_lshlrev_b32 v218, 16, v218
    v_lshlrev_b32 v219, 16, v219
    v_lshlrev_b32 v220, 16, v220
    v_lshlrev_b32 v221, 16, v221
    v_lshlrev_b32 v222, 16, v222
    v_lshlrev_b32 v223, 16, v223
    v_rcp_f32 v208, v216
    v_rcp_f32 v209, v217
    v_rcp_f32 v210, v218
    v_rcp_f32 v211, v219
    v_rcp_f32 v212, v220
    v_rcp_f32 v213, v221
    v_rcp_f32 v214, v222
    v_rcp_f32 v215, v223
    s_nop 0
    s_waitcnt vmcnt(5)
    ds_write_b128 v6, v[32:35] offset:9728
    ds_write_b128 v6, v[36:39] offset:13824
    v_lshlrev_b32 v16, 16, v32
    v_and_b32 v17, 0xffff0000, v32
    v_lshlrev_b32 v18, 16, v33
    v_and_b32 v19, 0xffff0000, v33
    v_lshlrev_b32 v20, 16, v34
    v_and_b32 v21, 0xffff0000, v34
    v_lshlrev_b32 v22, 16, v35
    v_and_b32 v23, 0xffff0000, v35
    v_sub_f32 v16, v16, v200
    v_sub_f32 v17, v17, v201
    v_sub_f32 v18, v18, v202
    v_sub_f32 v19, v19, v203
    v_sub_f32 v20, v20, v204
    v_sub_f32 v21, v21, v205
    v_sub_f32 v22, v22, v206
    v_sub_f32 v23, v23, v207
    v_cvt_pk_bf16_f32 v24, v16, v17
    v_cvt_pk_bf16_f32 v25, v18, v19
    v_cvt_pk_bf16_f32 v26, v20, v21
    v_cvt_pk_bf16_f32 v27, v22, v23
    v_lshlrev_b32 v16, 16, v24
    v_and_b32 v17, 0xffff0000, v24
    v_lshlrev_b32 v18, 16, v25
    v_and_b32 v19, 0xffff0000, v25
    v_lshlrev_b32 v20, 16, v26
    v_and_b32 v21, 0xffff0000, v26
    v_lshlrev_b32 v22, 16, v27
    v_and_b32 v23, 0xffff0000, v27
    v_mul_f32 v24, v16, v208
    v_mul_f32 v25, v17, v209
    v_mul_f32 v26, v18, v210
    v_mul_f32 v27, v19, v211
    v_mul_f32 v28, v20, v212
    v_mul_f32 v29, v21, v213
    v_mul_f32 v30, v22, v214
    v_mul_f32 v31, v23, v215
    v_fma_f32 v16, -v24, v216, v16
    v_fma_f32 v17, -v25, v217, v17
    v_fma_f32 v18, -v26, v218, v18
    v_fma_f32 v19, -v27, v219, v19
    v_fma_f32 v20, -v28, v220, v20
    v_fma_f32 v21, -v29, v221, v21
    v_fma_f32 v22, -v30, v222, v22
    v_fma_f32 v23, -v31, v223, v23
    v_fma_f32 v24, v16, v208, v24
    v_fma_f32 v25, v17, v209, v25
    v_fma_f32 v26, v18, v210, v26
    v_fma_f32 v27, v19, v211, v27
    v_fma_f32 v28, v20, v212, v28
    v_fma_f32 v29, v21, v213, v29
    v_fma_f32 v30, v22, v214, v30
    v_fma_f32 v31, v23, v215, v31
    v_cvt_pk_bf16_f32 v12, v24, v25
    v_cvt_pk_bf16_f32 v13, v26, v27
    v_cvt_pk_bf16_f32 v14, v28, v29
    v_cvt_pk_bf16_f32 v15, v30, v31
    ds_write_b128 v6, v[12:15] offset:1024
    v_lshlrev_b32 v16, 16, v36
    v_and_b32 v17, 0xffff0000, v36
    v_lshlrev_b32 v18, 16, v37
    v_and_b32 v19, 0xffff0000, v37
    v_lshlrev_b32 v20, 16, v38
    v_and_b32 v21, 0xffff0000, v38
    v_lshlrev_b32 v22, 16, v39
    v_and_b32 v23, 0xffff0000, v39
    v_sub_f32 v16, v16, v200
    v_sub_f32 v17, v17, v201
    v_sub_f32 v18, v18, v202
    v_sub_f32 v19, v19, v203
    v_sub_f32 v20, v20, v204
    v_sub_f32 v21, v21, v205
    v_sub_f32 v22, v22, v206
    v_sub_f32 v23, v23, v207
    v_cvt_pk_bf16_f32 v24, v16, v17
    v_cvt_pk_bf16_f32 v25, v18, v19
    v_cvt_pk_bf16_f32 v26, v20, v21
    v_cvt_pk_bf16_f32 v27, v22, v23
    v_lshlrev_b32 v16, 16, v24
    v_and_b32 v17, 0xffff0000, v24
    v_lshlrev_b32 v18, 16, v25
    v_and_b32 v19, 0xffff0000, v25
    v_lshlrev_b32 v20, 16, v26
    v_and_b32 v21, 0xffff0000, v26
    v_lshlrev_b32 v22, 16, v27
    v_and_b32 v23, 0xffff0000, v27
    v_mul_f32 v24, v16, v208
    v_mul_f32 v25, v17, v209
    v_mul_f32 v26, v18, v210
    v_mul_f32 v27, v19, v211
    v_mul_f32 v28, v20, v212
    v_mul_f32 v29, v21, v213
    v_mul_f32 v30, v22, v214
    v_mul_f32 v31, v23, v215
    v_fma_f32 v16, -v24, v216, v16
    v_fma_f32 v17, -v25, v217, v17
    v_fma_f32 v18, -v26, v218, v18
    v_fma_f32 v19, -v27, v219, v19
    v_fma_f32 v20, -v28, v220, v20
    v_fma_f32 v21, -v29, v221, v21
    v_fma_f32 v22, -v30, v222, v22
    v_fma_f32 v23, -v31, v223, v23
    v_fma_f32 v24, v16, v208, v24
    v_fma_f32 v25, v17, v209, v25
    v_fma_f32 v26, v18, v210, v26
    v_fma_f32 v27, v19, v211, v27
    v_fma_f32 v28, v20, v212, v28
    v_fma_f32 v29, v21, v213, v29
    v_fma_f32 v30, v22, v214, v30
    v_fma_f32 v31, v23, v215, v31
    v_cvt_pk_bf16_f32 v12, v24, v25
    v_cvt_pk_bf16_f32 v13, v26, v27
    v_cvt_pk_bf16_f32 v14, v28, v29
    v_cvt_pk_bf16_f32 v15, v30, v31
    ds_write_b128 v6, v[12:15] offset:5632
    v_add_u32 v7, 34304, v6
    s_waitcnt vmcnt(3)
    ds_write_b128 v7, v[40:43] offset:0
    v_alignbit_b32 v84, v41, v40, 16
    v_alignbit_b32 v85, v42, v41, 16
    v_alignbit_b32 v86, v43, v42, 16
    v_alignbit_b32 v87, v44, v43, 16
    ds_write_b128 v7, v[84:87] offset:4256
    v_mov_b32 v88, v41
    v_mov_b32 v89, v42
    v_mov_b32 v90, v43
    v_mov_b32 v91, v44
    ds_write_b128 v7, v[88:91] offset:8512
    v_alignbit_b32 v92, v42, v41, 16
    v_alignbit_b32 v93, v43, v42, 16
    v_alignbit_b32 v94, v44, v43, 16
    v_alignbit_b32 v95, v45, v44, 16
    ds_write_b128 v7, v[92:95] offset:12768
    ds_write_b128 v7, v[42:45] offset:17024
    v_alignbit_b32 v100, v43, v42, 16
    v_alignbit_b32 v101, v44, v43, 16
    v_alignbit_b32 v102, v45, v44, 16
    v_alignbit_b32 v103, v46, v45, 16
    ds_write_b128 v7, v[100:103] offset:21280
    v_mov_b32 v104, v43
    v_mov_b32 v105, v44
    v_mov_b32 v106, v45
    v_mov_b32 v107, v46
    ds_write_b128 v7, v[104:107] offset:25536
    v_alignbit_b32 v108, v44, v43, 16
    v_alignbit_b32 v109, v45, v44, 16
    v_alignbit_b32 v110, v46, v45, 16
    v_alignbit_b32 v111, v47, v46, 16
    ds_write_b128 v7, v[108:111] offset:29792
    s_waitcnt vmcnt(1)
    v_add_u32 v7, 34048, v7
    ds_write_b128 v7, v[48:51] offset:0
    v_alignbit_b32 v84, v49, v48, 16
    v_alignbit_b32 v85, v50, v49, 16
    v_alignbit_b32 v86, v51, v50, 16
    v_alignbit_b32 v87, v52, v51, 16
    ds_write_b128 v7, v[84:87] offset:4256
    v_mov_b32 v88, v49
    v_mov_b32 v89, v50
    v_mov_b32 v90, v51
    v_mov_b32 v91, v52
    ds_write_b128 v7, v[88:91] offset:8512
    v_alignbit_b32 v92, v50, v49, 16
    v_alignbit_b32 v93, v51, v50, 16
    v_alignbit_b32 v94, v52, v51, 16
    v_alignbit_b32 v95, v53, v52, 16
    ds_write_b128 v7, v[92:95] offset:12768
    ds_write_b128 v7, v[50:53] offset:17024
    v_alignbit_b32 v100, v51, v50, 16
    v_alignbit_b32 v101, v52, v51, 16
    v_alignbit_b32 v102, v53, v52, 16
    v_alignbit_b32 v103, v54, v53, 16
    ds_write_b128 v7, v[100:103] offset:21280
    v_mov_b32 v104, v51
    v_mov_b32 v105, v52
    v_mov_b32 v106, v53
    v_mov_b32 v107, v54
    ds_write_b128 v7, v[104:107] offset:25536
    v_alignbit_b32 v108, v52, v51, 16
    v_alignbit_b32 v109, v53, v52, 16
    v_alignbit_b32 v110, v54, v53, 16
    v_alignbit_b32 v111, v55, v54, 16
    ds_write_b128 v7, v[108:111] offset:29792
    s_lshr_b32 s26, s3, 1
    s_and_b32 s27, s3, 1
    s_lshl_b32 s29, s27, 8
    v_and_b32 v9, 7, v2
    v_sub_u32 v9, 7, v9
    v_mul_u32_u24 v9, 4256, v9
    v_lshrrev_b32 v10, 3, v2
    v_sub_u32 v10, v3, v10
    v_lshl_add_u32 v9, v10, 4, v9
    s_mul_i32 s28, s26, 34048
    s_add_u32 s28, s28, 34576
    s_sub_u32 s28, s28, s29
    v_add_u32 v9, s28, v9
    v_lshlrev_b32 v10, 5, v2
    v_lshl_add_u32 v10, v3, 4, v10
    s_mul_i32 s28, s26, 4608
    s_add_u32 s28, s28, 544
    s_sub_u32 s28, s28, s29
    v_add_u32 v10, s28, v10
    s_waitcnt lgkmcnt(0)
    s_barrier
    ds_read_b128 v[128:131], v10 offset:448
    ds_read_b128 v[96:99], v9 offset:3776
    ds_read_b128 v[132:135], v10 offset:960
    ds_read_b128 v[100:103], v9 offset:3264
    ds_read_b128 v[136:139], v10 offset:1472
    ds_read_b128 v[104:107], v9 offset:2752
    ds_read_b128 v[140:143], v10 offset:1984
    ds_read_b128 v[108:111], v9 offset:2240
    ds_read_b128 v[144:147], v10 offset:2496
    ds_read_b128 v[112:115], v9 offset:1728
    ds_read_b128 v[148:151], v10 offset:3008
    ds_read_b128 v[116:119], v9 offset:1216
    ds_read_b128 v[152:155], v10 offset:3520
    ds_read_b128 v[120:123], v9 offset:704
    ds_read_b128 v[156:159], v10 offset:4032
    ds_read_b128 v[124:127], v9 offset:192
    s_waitcnt lgkmcnt(0)
    v_mfma_f32_16x16x32_bf16 a[0:3], v[96:99], v[128:131], 0
    v_mfma_f32_16x16x32_bf16 a[4:7], v[96:99], v[132:135], 0
    ds_read_b128 v[192:195], v10 offset:384
    v_mfma_f32_16x16x32_bf16 a[8:11], v[96:99], v[136:139], 0
    v_mfma_f32_16x16x32_bf16 a[12:15], v[96:99], v[140:143], 0
    ds_read_b128 v[160:163], v9 offset:3712
    v_mfma_f32_16x16x32_bf16 a[16:19], v[96:99], v[144:147], 0
    v_mfma_f32_16x16x32_bf16 a[20:23], v[96:99], v[148:151], 0
    ds_read_b128 v[196:199], v10 offset:896
    v_mfma_f32_16x16x32_bf16 a[24:27], v[96:99], v[152:155], 0
    v_mfma_f32_16x16x32_bf16 a[28:31], v[96:99], v[156:159], 0
    ds_read_b128 v[164:167], v9 offset:3200
    v_mfma_f32_16x16x32_bf16 a[4:7], v[100:103], v[128:131], a[4:7]
    v_mfma_f32_16x16x32_bf16 a[8:11], v[100:103], v[132:135], a[8:11]
    ds_read_b128 v[200:203], v10 offset:1408
    v_mfma_f32_16x16x32_bf16 a[12:15], v[100:103], v[136:139], a[12:15]
    v_mfma_f32_16x16x32_bf16 a[16:19], v[100:103], v[140:143], a[16:19]
    ds_read_b128 v[168:171], v9 offset:2688
    v_mfma_f32_16x16x32_bf16 a[20:23], v[100:103], v[144:147], a[20:23]
    v_mfma_f32_16x16x32_bf16 a[24:27], v[100:103], v[148:151], a[24:27]
    ds_read_b128 v[204:207], v10 offset:1920
    v_mfma_f32_16x16x32_bf16 a[28:31], v[100:103], v[152:155], a[28:31]
    v_mfma_f32_16x16x32_bf16 a[8:11], v[104:107], v[128:131], a[8:11]
    ds_read_b128 v[172:175], v9 offset:2176
    v_mfma_f32_16x16x32_bf16 a[12:15], v[104:107], v[132:135], a[12:15]
    v_mfma_f32_16x16x32_bf16 a[16:19], v[104:107], v[136:139], a[16:19]
    ds_read_b128 v[208:211], v10 offset:2432
    v_mfma_f32_16x16x32_bf16 a[20:23], v[104:107], v[140:143], a[20:23]
    v_mfma_f32_16x16x32_bf16 a[24:27], v[104:107], v[144:147], a[24:27]
    ds_read_b128 v[176:179], v9 offset:1664
    v_mfma_f32_16x16x32_bf16 a[28:31], v[104:107], v[148:151], a[28:31]
    v_mfma_f32_16x16x32_bf16 a[12:15], v[108:111], v[128:131], a[12:15]
    ds_read_b128 v[212:215], v10 offset:2944
    v_mfma_f32_16x16x32_bf16 a[16:19], v[108:111], v[132:135], a[16:19]
    v_mfma_f32_16x16x32_bf16 a[20:23], v[108:111], v[136:139], a[20:23]
    ds_read_b128 v[180:183], v9 offset:1152
    v_mfma_f32_16x16x32_bf16 a[24:27], v[108:111], v[140:143], a[24:27]
    v_mfma_f32_16x16x32_bf16 a[28:31], v[108:111], v[144:147], a[28:31]
    ds_read_b128 v[216:219], v10 offset:3456
    v_mfma_f32_16x16x32_bf16 a[16:19], v[112:115], v[128:131], a[16:19]
    v_mfma_f32_16x16x32_bf16 a[20:23], v[112:115], v[132:135], a[20:23]
    ds_read_b128 v[184:187], v9 offset:640
    v_mfma_f32_16x16x32_bf16 a[24:27], v[112:115], v[136:139], a[24:27]
    v_mfma_f32_16x16x32_bf16 a[28:31], v[112:115], v[140:143], a[28:31]
    ds_read_b128 v[220:223], v10 offset:3968
    v_mfma_f32_16x16x32_bf16 a[20:23], v[116:119], v[128:131], a[20:23]
    v_mfma_f32_16x16x32_bf16 a[24:27], v[116:119], v[132:135], a[24:27]
    ds_read_b128 v[188:191], v9 offset:128
    v_mfma_f32_16x16x32_bf16 a[28:31], v[116:119], v[136:139], a[28:31]
    v_mfma_f32_16x16x32_bf16 a[24:27], v[120:123], v[128:131], a[24:27]
    v_mfma_f32_16x16x32_bf16 a[28:31], v[120:123], v[132:135], a[28:31]
    v_mfma_f32_16x16x32_bf16 a[28:31], v[124:127], v[128:131], a[28:31]
    s_waitcnt lgkmcnt(0)
    v_mfma_f32_16x16x32_bf16 a[0:3], v[160:163], v[192:195], a[0:3]
    v_mfma_f32_16x16x32_bf16 a[4:7], v[160:163], v[196:199], a[4:7]
    ds_read_b128 v[128:131], v10 offset:320
    v_mfma_f32_16x16x32_bf16 a[8:11], v[160:163], v[200:203], a[8:11]
    v_mfma_f32_16x16x32_bf16 a[12:15], v[160:163], v[204:207], a[12:15]
    ds_read_b128 v[96:99], v9 offset:3648
    v_mfma_f32_16x16x32_bf16 a[16:19], v[160:163], v[208:211], a[16:19]
    v_mfma_f32_16x16x32_bf16 a[20:23], v[160:163], v[212:215], a[20:23]
    ds_read_b128 v[132:135], v10 offset:832
    v_mfma_f32_16x16x32_bf16 a[24:27], v[160:163], v[216:219], a[24:27]
    v_mfma_f32_16x16x32_bf16 a[28:31], v[160:163], v[220:223], a[28:31]
    ds_read_b128 v[100:103], v9 offset:3136
    v_mfma_f32_16x16x32_bf16 a[4:7], v[164:167], v[192:195], a[4:7]
    v_mfma_f32_16x16x32_bf16 a[8:11], v[164:167], v[196:199], a[8:11]
    ds_read_b128 v[136:139], v10 offset:1344
    v_mfma_f32_16x16x32_bf16 a[12:15], v[164:167], v[200:203], a[12:15]
    v_mfma_f32_16x16x32_bf16 a[16:19], v[164:167], v[204:207], a[16:19]
    ds_read_b128 v[104:107], v9 offset:2624
    v_mfma_f32_16x16x32_bf16 a[20:23], v[164:167], v[208:211], a[20:23]
    v_mfma_f32_16x16x32_bf16 a[24:27], v[164:167], v[212:215], a[24:27]
    ds_read_b128 v[140:143], v10 offset:1856
    v_mfma_f32_16x16x32_bf16 a[28:31], v[164:167], v[216:219], a[28:31]
    v_mfma_f32_16x16x32_bf16 a[8:11], v[168:171], v[192:195], a[8:11]
    ds_read_b128 v[108:111], v9 offset:2112
    v_mfma_f32_16x16x32_bf16 a[12:15], v[168:171], v[196:199], a[12:15]
    v_mfma_f32_16x16x32_bf16 a[16:19], v[168:171], v[200:203], a[16:19]
    ds_read_b128 v[144:147], v10 offset:2368
    v_mfma_f32_16x16x32_bf16 a[20:23], v[168:171], v[204:207], a[20:23]
    v_mfma_f32_16x16x32_bf16 a[24:27], v[168:171], v[208:211], a[24:27]
    ds_read_b128 v[112:115], v9 offset:1600
    v_mfma_f32_16x16x32_bf16 a[28:31], v[168:171], v[212:215], a[28:31]
    v_mfma_f32_16x16x32_bf16 a[12:15], v[172:175], v[192:195], a[12:15]
    ds_read_b128 v[148:151], v10 offset:2880
    v_mfma_f32_16x16x32_bf16 a[16:19], v[172:175], v[196:199], a[16:19]
    v_mfma_f32_16x16x32_bf16 a[20:23], v[172:175], v[200:203], a[20:23]
    ds_read_b128 v[116:119], v9 offset:1088
    v_mfma_f32_16x16x32_bf16 a[24:27], v[172:175], v[204:207], a[24:27]
    v_mfma_f32_16x16x32_bf16 a[28:31], v[172:175], v[208:211], a[28:31]
    ds_read_b128 v[152:155], v10 offset:3392
    v_mfma_f32_16x16x32_bf16 a[16:19], v[176:179], v[192:195], a[16:19]
    v_mfma_f32_16x16x32_bf16 a[20:23], v[176:179], v[196:199], a[20:23]
    ds_read_b128 v[120:123], v9 offset:576
    v_mfma_f32_16x16x32_bf16 a[24:27], v[176:179], v[200:203], a[24:27]
    v_mfma_f32_16x16x32_bf16 a[28:31], v[176:179], v[204:207], a[28:31]
    ds_read_b128 v[156:159], v10 offset:3904
    v_mfma_f32_16x16x32_bf16 a[20:23], v[180:183], v[192:195], a[20:23]
    v_mfma_f32_16x16x32_bf16 a[24:27], v[180:183], v[196:199], a[24:27]
    ds_read_b128 v[124:127], v9 offset:64
    v_mfma_f32_16x16x32_bf16 a[28:31], v[180:183], v[200:203], a[28:31]
    v_mfma_f32_16x16x32_bf16 a[24:27], v[184:187], v[192:195], a[24:27]
    v_mfma_f32_16x16x32_bf16 a[28:31], v[184:187], v[196:199], a[28:31]
    v_mfma_f32_16x16x32_bf16 a[28:31], v[188:191], v[192:195], a[28:31]
    s_waitcnt lgkmcnt(0)
    v_mfma_f32_16x16x32_bf16 a[0:3], v[96:99], v[128:131], a[0:3]
    v_mfma_f32_16x16x32_bf16 a[4:7], v[96:99], v[132:135], a[4:7]
    ds_read_b128 v[192:195], v10 offset:256
    v_mfma_f32_16x16x32_bf16 a[8:11], v[96:99], v[136:139], a[8:11]
    v_mfma_f32_16x16x32_bf16 a[12:15], v[96:99], v[140:143], a[12:15]
    ds_read_b128 v[160:163], v9 offset:3584
    v_mfma_f32_16x16x32_bf16 a[16:19], v[96:99], v[144:147], a[16:19]
    v_mfma_f32_16x16x32_bf16 a[20:23], v[96:99], v[148:151], a[20:23]
    ds_read_b128 v[196:199], v10 offset:768
    v_mfma_f32_16x16x32_bf16 a[24:27], v[96:99], v[152:155], a[24:27]
    v_mfma_f32_16x16x32_bf16 a[28:31], v[96:99], v[156:159], a[28:31]
    ds_read_b128 v[164:167], v9 offset:3072
    v_mfma_f32_16x16x32_bf16 a[4:7], v[100:103], v[128:131], a[4:7]
    v_mfma_f32_16x16x32_bf16 a[8:11], v[100:103], v[132:135], a[8:11]
    ds_read_b128 v[200:203], v10 offset:1280
    v_mfma_f32_16x16x32_bf16 a[12:15], v[100:103], v[136:139], a[12:15]
    v_mfma_f32_16x16x32_bf16 a[16:19], v[100:103], v[140:143], a[16:19]
    ds_read_b128 v[168:171], v9 offset:2560
    v_mfma_f32_16x16x32_bf16 a[20:23], v[100:103], v[144:147], a[20:23]
    v_mfma_f32_16x16x32_bf16 a[24:27], v[100:103], v[148:151], a[24:27]
    ds_read_b128 v[204:207], v10 offset:1792
    v_mfma_f32_16x16x32_bf16 a[28:31], v[100:103], v[152:155], a[28:31]
    v_mfma_f32_16x16x32_bf16 a[8:11], v[104:107], v[128:131], a[8:11]
    ds_read_b128 v[172:175], v9 offset:2048
    v_mfma_f32_16x16x32_bf16 a[12:15], v[104:107], v[132:135], a[12:15]
    v_mfma_f32_16x16x32_bf16 a[16:19], v[104:107], v[136:139], a[16:19]
    ds_read_b128 v[208:211], v10 offset:2304
    v_mfma_f32_16x16x32_bf16 a[20:23], v[104:107], v[140:143], a[20:23]
    v_mfma_f32_16x16x32_bf16 a[24:27], v[104:107], v[144:147], a[24:27]
    ds_read_b128 v[176:179], v9 offset:1536
    v_mfma_f32_16x16x32_bf16 a[28:31], v[104:107], v[148:151], a[28:31]
    v_mfma_f32_16x16x32_bf16 a[12:15], v[108:111], v[128:131], a[12:15]
    ds_read_b128 v[212:215], v10 offset:2816
    v_mfma_f32_16x16x32_bf16 a[16:19], v[108:111], v[132:135], a[16:19]
    v_mfma_f32_16x16x32_bf16 a[20:23], v[108:111], v[136:139], a[20:23]
    ds_read_b128 v[180:183], v9 offset:1024
    v_mfma_f32_16x16x32_bf16 a[24:27], v[108:111], v[140:143], a[24:27]
    v_mfma_f32_16x16x32_bf16 a[28:31], v[108:111], v[144:147], a[28:31]
    ds_read_b128 v[216:219], v10 offset:3328
    v_mfma_f32_16x16x32_bf16 a[16:19], v[112:115], v[128:131], a[16:19]
    v_mfma_f32_16x16x32_bf16 a[20:23], v[112:115], v[132:135], a[20:23]
    ds_read_b128 v[184:187], v9 offset:512
    v_mfma_f32_16x16x32_bf16 a[24:27], v[112:115], v[136:139], a[24:27]
    v_mfma_f32_16x16x32_bf16 a[28:31], v[112:115], v[140:143], a[28:31]
    ds_read_b128 v[220:223], v10 offset:3840
    v_mfma_f32_16x16x32_bf16 a[20:23], v[116:119], v[128:131], a[20:23]
    v_mfma_f32_16x16x32_bf16 a[24:27], v[116:119], v[132:135], a[24:27]
    ds_read_b128 v[188:191], v9 offset:0
    v_mfma_f32_16x16x32_bf16 a[28:31], v[116:119], v[136:139], a[28:31]
    v_mfma_f32_16x16x32_bf16 a[24:27], v[120:123], v[128:131], a[24:27]
    v_mfma_f32_16x16x32_bf16 a[28:31], v[120:123], v[132:135], a[28:31]
    v_mfma_f32_16x16x32_bf16 a[28:31], v[124:127], v[128:131], a[28:31]
    s_waitcnt lgkmcnt(0)
    v_mfma_f32_16x16x32_bf16 a[0:3], v[160:163], v[192:195], a[0:3]
    v_mfma_f32_16x16x32_bf16 a[4:7], v[160:163], v[196:199], a[4:7]
    v_mfma_f32_16x16x32_bf16 a[8:11], v[160:163], v[200:203], a[8:11]
    v_mfma_f32_16x16x32_bf16 a[12:15], v[160:163], v[204:207], a[12:15]
    v_mfma_f32_16x16x32_bf16 a[16:19], v[160:163], v[208:211], a[16:19]
    v_mfma_f32_16x16x32_bf16 a[20:23], v[160:163], v[212:215], a[20:23]
    v_mfma_f32_16x16x32_bf16 a[24:27], v[160:163], v[216:219], a[24:27]
    v_mfma_f32_16x16x32_bf16 a[28:31], v[160:163], v[220:223], a[28:31]
    v_mfma_f32_16x16x32_bf16 a[4:7], v[164:167], v[192:195], a[4:7]
    v_mfma_f32_16x16x32_bf16 a[8:11], v[164:167], v[196:199], a[8:11]
    v_mfma_f32_16x16x32_bf16 a[12:15], v[164:167], v[200:203], a[12:15]
    v_mfma_f32_16x16x32_bf16 a[16:19], v[164:167], v[204:207], a[16:19]
    v_mfma_f32_16x16x32_bf16 a[20:23], v[164:167], v[208:211], a[20:23]
    v_mfma_f32_16x16x32_bf16 a[24:27], v[164:167], v[212:215], a[24:27]
    v_mfma_f32_16x16x32_bf16 a[28:31], v[164:167], v[216:219], a[28:31]
    v_mfma_f32_16x16x32_bf16 a[8:11], v[168:171], v[192:195], a[8:11]
    v_mfma_f32_16x16x32_bf16 a[12:15], v[168:171], v[196:199], a[12:15]
    v_mfma_f32_16x16x32_bf16 a[16:19], v[168:171], v[200:203], a[16:19]
    v_mfma_f32_16x16x32_bf16 a[20:23], v[168:171], v[204:207], a[20:23]
    v_mfma_f32_16x16x32_bf16 a[24:27], v[168:171], v[208:211], a[24:27]
    v_mfma_f32_16x16x32_bf16 a[28:31], v[168:171], v[212:215], a[28:31]
    v_mfma_f32_16x16x32_bf16 a[12:15], v[172:175], v[192:195], a[12:15]
    v_mfma_f32_16x16x32_bf16 a[16:19], v[172:175], v[196:199], a[16:19]
    v_mfma_f32_16x16x32_bf16 a[20:23], v[172:175], v[200:203], a[20:23]
    v_mfma_f32_16x16x32_bf16 a[24:27], v[172:175], v[204:207], a[24:27]
    v_mfma_f32_16x16x32_bf16 a[28:31], v[172:175], v[208:211], a[28:31]
    v_mfma_f32_16x16x32_bf16 a[16:19], v[176:179], v[192:195], a[16:19]
    v_mfma_f32_16x16x32_bf16 a[20:23], v[176:179], v[196:199], a[20:23]
    v_mfma_f32_16x16x32_bf16 a[24:27], v[176:179], v[200:203], a[24:27]
    v_mfma_f32_16x16x32_bf16 a[28:31], v[176:179], v[204:207], a[28:31]
    v_mfma_f32_16x16x32_bf16 a[20:23], v[180:183], v[192:195], a[20:23]
    v_mfma_f32_16x16x32_bf16 a[24:27], v[180:183], v[196:199], a[24:27]
    v_mfma_f32_16x16x32_bf16 a[28:31], v[180:183], v[200:203], a[28:31]
    v_mfma_f32_16x16x32_bf16 a[24:27], v[184:187], v[192:195], a[24:27]
    v_mfma_f32_16x16x32_bf16 a[28:31], v[184:187], v[196:199], a[28:31]
    v_mfma_f32_16x16x32_bf16 a[28:31], v[188:191], v[192:195], a[28:31]
    v_lshlrev_b32 v11, 4, v1
    s_lshl_b32 s28, s3, 12
    v_add_u32 v12, s28, v11
    s_xor_b32 s28, s3, 1
    s_lshl_b32 s28, s28, 12
    v_add_u32 v13, s28, v11
    v_lshlrev_b32 v14, 5, v2
    v_lshl_add_u32 v14, v3, 3, v14
    s_lshl_b32 s28, s27, 11
    v_add_u32 v14, s28, v14
    s_mul_i32 s28, s26, 4608
    v_add_u32 v15, s28, v14
    s_lshl_b32 s28, s26, 12
    v_add_u32 v16, s28, v14
    s_mul_i32 s28, s26, 4352
    v_add_u32 v17, s28, v14
    ds_read_b64 v[32:33], v15 offset:1024
    ds_read_b64 v[40:41], v16 offset:9728
    ds_read_b64 v[34:35], v15 offset:1536
    ds_read_b64 v[42:43], v16 offset:10240
    ds_read_b64 v[36:37], v15 offset:2048
    ds_read_b64 v[44:45], v16 offset:10752
    ds_read_b64 v[38:39], v15 offset:2560
    ds_read_b64 v[46:47], v16 offset:11264
    s_cmp_eq_u32 s27, 0
    s_cbranch_scc1 L_conv_kernel_h0
    ds_write_b128 v12, a[0:3] offset:17920
    ds_write_b128 v12, a[4:7] offset:18944
    ds_write_b128 v12, a[8:11] offset:19968
    ds_write_b128 v12, a[12:15] offset:20992
    v_accvgpr_read_b32 v64, a16
    v_accvgpr_read_b32 v65, a17
    v_accvgpr_read_b32 v66, a18
    v_accvgpr_read_b32 v67, a19
    v_accvgpr_read_b32 v68, a20
    v_accvgpr_read_b32 v69, a21
    v_accvgpr_read_b32 v70, a22
    v_accvgpr_read_b32 v71, a23
    v_accvgpr_read_b32 v72, a24
    v_accvgpr_read_b32 v73, a25
    v_accvgpr_read_b32 v74, a26
    v_accvgpr_read_b32 v75, a27
    v_accvgpr_read_b32 v76, a28
    v_accvgpr_read_b32 v77, a29
    v_accvgpr_read_b32 v78, a30
    v_accvgpr_read_b32 v79, a31
    s_branch L_conv_kernel_h1
L_conv_kernel_h0:
    ds_write_b128 v12, a[16:19] offset:17920
    ds_write_b128 v12, a[20:23] offset:18944
    ds_write_b128 v12, a[24:27] offset:19968
    ds_write_b128 v12, a[28:31] offset:20992
    v_accvgpr_read_b32 v64, a0
    v_accvgpr_read_b32 v65, a1
    v_accvgpr_read_b32 v66, a2
    v_accvgpr_read_b32 v67, a3
    v_accvgpr_read_b32 v68, a4
    v_accvgpr_read_b32 v69, a5
    v_accvgpr_read_b32 v70, a6
    v_accvgpr_read_b32 v71, a7
    v_accvgpr_read_b32 v72, a8
    v_accvgpr_read_b32 v73, a9
    v_accvgpr_read_b32 v74, a10
    v_accvgpr_read_b32 v75, a11
    v_accvgpr_read_b32 v76, a12
    v_accvgpr_read_b32 v77, a13
    v_accvgpr_read_b32 v78, a14
    v_accvgpr_read_b32 v79, a15
L_conv_kernel_h1:
    s_waitcnt lgkmcnt(0)
    s_barrier
    ds_read_b128 v[96:99], v13 offset:17920
    ds_read_b128 v[100:103], v13 offset:18944
    ds_read_b128 v[104:107], v13 offset:19968
    ds_read_b128 v[108:111], v13 offset:20992
    s_waitcnt vmcnt(0)
    v_lshlrev_b32 v57, 16, v56
    v_and_b32 v58, 0xffff0000, v56
    s_cmp_eq_u32 s26, 0
    s_cbranch_scc1 L_conv_kernel_c0
    v_mov_b32 v57, v58
L_conv_kernel_c0:
    s_waitcnt lgkmcnt(0)
    s_add_u32 s18, s17, 0x240000
    v_add_f32 v64, v64, v96
    v_lshlrev_b32 v20, 16, v32
    v_lshlrev_b32 v24, 16, v40
    v_mul_f32 v20, v20, v57
    v_add_f32 v65, v65, v97
    v_and_b32 v21, 0xffff0000, v32
    v_and_b32 v25, 0xffff0000, v40
    v_mul_f32 v21, v21, v57
    v_add_f32 v66, v66, v98
    v_lshlrev_b32 v22, 16, v33
    v_lshlrev_b32 v26, 16, v41
    v_mul_f32 v22, v22, v57
    v_add_f32 v67, v67, v99
    v_and_b32 v23, 0xffff0000, v33
    v_and_b32 v27, 0xffff0000, v41
    v_mul_f32 v23, v23, v57
    v_cvt_pk_bf16_f32 v64, v64, v64
    v_lshlrev_b32 v64, 16, v64
    v_cvt_pk_bf16_f32 v20, v20, v20
    v_lshlrev_b32 v20, 16, v20
    v_cvt_pk_bf16_f32 v65, v65, v65
    v_lshlrev_b32 v65, 16, v65
    v_cvt_pk_bf16_f32 v21, v21, v21
    v_lshlrev_b32 v21, 16, v21
    v_cvt_pk_bf16_f32 v66, v66, v66
    v_lshlrev_b32 v66, 16, v66
    v_cvt_pk_bf16_f32 v22, v22, v22
    v_lshlrev_b32 v22, 16, v22
    v_cvt_pk_bf16_f32 v67, v67, v67
    v_lshlrev_b32 v67, 16, v67
    v_cvt_pk_bf16_f32 v23, v23, v23
    v_lshlrev_b32 v23, 16, v23
    v_add_f32 v20, v20, v64
    v_add_f32 v21, v21, v65
    v_add_f32 v22, v22, v66
    v_add_f32 v23, v23, v67
    v_cvt_pk_bf16_f32 v20, v20, v20
    v_lshlrev_b32 v20, 16, v20
    v_cvt_pk_bf16_f32 v21, v21, v21
    v_lshlrev_b32 v21, 16, v21
    v_cvt_pk_bf16_f32 v22, v22, v22
    v_lshlrev_b32 v22, 16, v22
    v_cvt_pk_bf16_f32 v23, v23, v23
    v_lshlrev_b32 v23, 16, v23
    v_add_f32 v20, v20, v24
    v_add_f32 v21, v21, v25
    v_add_f32 v22, v22, v26
    v_add_f32 v23, v23, v27
    v_cvt_pk_bf16_f32 v48, v20, v21
    v_cvt_pk_bf16_f32 v49, v22, v23
    buffer_store_dwordx2 v[48:49], v17, s[4:7], s18 offen offset:0 sc1
    v_add_f32 v68, v68, v100
    v_lshlrev_b32 v20, 16, v34
    v_lshlrev_b32 v24, 16, v42
    v_mul_f32 v20, v20, v57
    v_add_f32 v69, v69, v101
    v_and_b32 v21, 0xffff0000, v34
    v_and_b32 v25, 0xffff0000, v42
    v_mul_f32 v21, v21, v57
    v_add_f32 v70, v70, v102
    v_lshlrev_b32 v22, 16, v35
    v_lshlrev_b32 v26, 16, v43
    v_mul_f32 v22, v22, v57
    v_add_f32 v71, v71, v103
    v_and_b32 v23, 0xffff0000, v35
    v_and_b32 v27, 0xffff0000, v43
    v_mul_f32 v23, v23, v57
    v_cvt_pk_bf16_f32 v68, v68, v68
    v_lshlrev_b32 v68, 16, v68
    v_cvt_pk_bf16_f32 v20, v20, v20
    v_lshlrev_b32 v20, 16, v20
    v_cvt_pk_bf16_f32 v69, v69, v69
    v_lshlrev_b32 v69, 16, v69
    v_cvt_pk_bf16_f32 v21, v21, v21
    v_lshlrev_b32 v21, 16, v21
    v_cvt_pk_bf16_f32 v70, v70, v70
    v_lshlrev_b32 v70, 16, v70
    v_cvt_pk_bf16_f32 v22, v22, v22
    v_lshlrev_b32 v22, 16, v22
    v_cvt_pk_bf16_f32 v71, v71, v71
    v_lshlrev_b32 v71, 16, v71
    v_cvt_pk_bf16_f32 v23, v23, v23
    v_lshlrev_b32 v23, 16, v23
    v_add_f32 v20, v20, v68
    v_add_f32 v21, v21, v69
    v_add_f32 v22, v22, v70
    v_add_f32 v23, v23, v71
    v_cvt_pk_bf16_f32 v20, v20, v20
    v_lshlrev_b32 v20, 16, v20
    v_cvt_pk_bf16_f32 v21, v21, v21
    v_lshlrev_b32 v21, 16, v21
    v_cvt_pk_bf16_f32 v22, v22, v22
    v_lshlrev_b32 v22, 16, v22
    v_cvt_pk_bf16_f32 v23, v23, v23
    v_lshlrev_b32 v23, 16, v23
    v_add_f32 v20, v20, v24
    v_add_f32 v21, v21, v25
    v_add_f32 v22, v22, v26
    v_add_f32 v23, v23, v27
    v_cvt_pk_bf16_f32 v50, v20, v21
    v_cvt_pk_bf16_f32 v51, v22, v23
    buffer_store_dwordx2 v[50:51], v17, s[4:7], s18 offen offset:512 sc1
    v_add_f32 v72, v72, v104
    v_lshlrev_b32 v20, 16, v36
    v_lshlrev_b32 v24, 16, v44
    v_mul_f32 v20, v20, v57
    v_add_f32 v73, v73, v105
    v_and_b32 v21, 0xffff0000, v36
    v_and_b32 v25, 0xffff0000, v44
    v_mul_f32 v21, v21, v57
    v_add_f32 v74, v74, v106
    v_lshlrev_b32 v22, 16, v37
    v_lshlrev_b32 v26, 16, v45
    v_mul_f32 v22, v22, v57
    v_add_f32 v75, v75, v107
    v_and_b32 v23, 0xffff0000, v37
    v_and_b32 v27, 0xffff0000, v45
    v_mul_f32 v23, v23, v57
    v_cvt_pk_bf16_f32 v72, v72, v72
    v_lshlrev_b32 v72, 16, v72
    v_cvt_pk_bf16_f32 v20, v20, v20
    v_lshlrev_b32 v20, 16, v20
    v_cvt_pk_bf16_f32 v73, v73, v73
    v_lshlrev_b32 v73, 16, v73
    v_cvt_pk_bf16_f32 v21, v21, v21
    v_lshlrev_b32 v21, 16, v21
    v_cvt_pk_bf16_f32 v74, v74, v74
    v_lshlrev_b32 v74, 16, v74
    v_cvt_pk_bf16_f32 v22, v22, v22
    v_lshlrev_b32 v22, 16, v22
    v_cvt_pk_bf16_f32 v75, v75, v75
    v_lshlrev_b32 v75, 16, v75
    v_cvt_pk_bf16_f32 v23, v23, v23
    v_lshlrev_b32 v23, 16, v23
    v_add_f32 v20, v20, v72
    v_add_f32 v21, v21, v73
    v_add_f32 v22, v22, v74
    v_add_f32 v23, v23, v75
    v_cvt_pk_bf16_f32 v20, v20, v20
    v_lshlrev_b32 v20, 16, v20
    v_cvt_pk_bf16_f32 v21, v21, v21
    v_lshlrev_b32 v21, 16, v21
    v_cvt_pk_bf16_f32 v22, v22, v22
    v_lshlrev_b32 v22, 16, v22
    v_cvt_pk_bf16_f32 v23, v23, v23
    v_lshlrev_b32 v23, 16, v23
    v_add_f32 v20, v20, v24
    v_add_f32 v21, v21, v25
    v_add_f32 v22, v22, v26
    v_add_f32 v23, v23, v27
    v_cvt_pk_bf16_f32 v52, v20, v21
    v_cvt_pk_bf16_f32 v53, v22, v23
    buffer_store_dwordx2 v[52:53], v17, s[4:7], s18 offen offset:1024 sc1
    v_add_f32 v76, v76, v108
    v_lshlrev_b32 v20, 16, v38
    v_lshlrev_b32 v24, 16, v46
    v_mul_f32 v20, v20, v57
    v_add_f32 v77, v77, v109
    v_and_b32 v21, 0xffff0000, v38
    v_and_b32 v25, 0xffff0000, v46
    v_mul_f32 v21, v21, v57
    v_add_f32 v78, v78, v110
    v_lshlrev_b32 v22, 16, v39
    v_lshlrev_b32 v26, 16, v47
    v_mul_f32 v22, v22, v57
    v_add_f32 v79, v79, v111
    v_and_b32 v23, 0xffff0000, v39
    v_and_b32 v27, 0xffff0000, v47
    v_mul_f32 v23, v23, v57
    v_cvt_pk_bf16_f32 v76, v76, v76
    v_lshlrev_b32 v76, 16, v76
    v_cvt_pk_bf16_f32 v20, v20, v20
    v_lshlrev_b32 v20, 16, v20
    v_cvt_pk_bf16_f32 v77, v77, v77
    v_lshlrev_b32 v77, 16, v77
    v_cvt_pk_bf16_f32 v21, v21, v21
    v_lshlrev_b32 v21, 16, v21
    v_cvt_pk_bf16_f32 v78, v78, v78
    v_lshlrev_b32 v78, 16, v78
    v_cvt_pk_bf16_f32 v22, v22, v22
    v_lshlrev_b32 v22, 16, v22
    v_cvt_pk_bf16_f32 v79, v79, v79
    v_lshlrev_b32 v79, 16, v79
    v_cvt_pk_bf16_f32 v23, v23, v23
    v_lshlrev_b32 v23, 16, v23
    v_add_f32 v20, v20, v76
    v_add_f32 v21, v21, v77
    v_add_f32 v22, v22, v78
    v_add_f32 v23, v23, v79
    v_cvt_pk_bf16_f32 v20, v20, v20
    v_lshlrev_b32 v20, 16, v20
    v_cvt_pk_bf16_f32 v21, v21, v21
    v_lshlrev_b32 v21, 16, v21
    v_cvt_pk_bf16_f32 v22, v22, v22
    v_lshlrev_b32 v22, 16, v22
    v_cvt_pk_bf16_f32 v23, v23, v23
    v_lshlrev_b32 v23, 16, v23
    v_add_f32 v20, v20, v24
    v_add_f32 v21, v21, v25
    v_add_f32 v22, v22, v26
    v_add_f32 v23, v23, v27
    v_cvt_pk_bf16_f32 v54, v20, v21
    v_cvt_pk_bf16_f32 v55, v22, v23
    buffer_store_dwordx2 v[54:55], v17, s[4:7], s18 offen offset:1536 sc1
    s_cmp_lg_u32 s2, 0
    s_cbranch_scc1 L_conv_kernel_nf
    v_mov_b32 v8, 0
    s_mov_b32 s20, 0x90c000
    buffer_load_dword v9, v8, s[4:7], s20 offen
    s_waitcnt vmcnt(0)
    buffer_store_dword v9, v8, s[4:7], s20 offen offset:4
L_conv_kernel_nf:
L_conv_kernel_end:
    s_endpgm

.globl g1_kernel
.p2align 8
.type g1_kernel,@function
g1_kernel:

    s_cmp_ge_u32 s2, 224
    s_cbranch_scc1 L_g1_kernel_end
    s_load_dwordx2 s[12:13], s[0:1], 96
    v_and_b32 v1, 63, v0
    v_lshrrev_b32 v4, 6, v0
    v_and_b32 v2, 15, v0
    v_bfe_u32 v3, v0, 4, 2
    v_readfirstlane_b32 s3, v4
    s_and_b32 s16, s2, 7
    s_lshl_b32 s16, s16, 1
    s_bfe_u32 s17, s2, 0x10003
    s_add_u32 s16, s16, s17
    s_lshr_b32 s17, s2, 4
    v_add_u32 v7, 0, v3
    v_lshlrev_b32 v8, 1, v7
    v_xor_b32 v8, v8, v2
    v_lshlrev_b32 v8, 4, v8
    v_mul_u32_u24 v7, 4352, v7
    v_add_u32 v5, v7, v8
    v_add_u32 v7, 4, v3
    v_lshlrev_b32 v8, 1, v7
    v_xor_b32 v8, v8, v2
    v_lshlrev_b32 v8, 4, v8
    v_mul_u32_u24 v7, 4352, v7
    v_add_u32 v6, v7, v8
    s_mul_i32 s18, s3, 34816
    s_lshl_b32 s19, s16, 8
    s_add_u32 s18, s18, s19
    s_add_u32 s18, s18, 0x240000
    s_lshl_b32 s20, s3, 11
    v_lshlrev_b32 v9, 4, v1
    s_lshl_b32 s21, s17, 2
    s_add_u32 s21, s21, s3
    s_mov_b32 s24, s21
    s_lshl_b32 s21, s21, 15
    s_add_u32 s21, s21, 0xc00000
    v_lshlrev_b32 v10, 4, v3
    s_lshl_b32 s22, s24, 7
    s_add_u32 s22, s22, 0x908000
    s_waitcnt lgkmcnt(0)
    s_mov_b32 s4, s12
    s_and_b32 s5, s13, 0xffff
    s_mov_b32 s6, 0x2000000
    s_mov_b32 s7, 0x00020000
    s_add_u32 s23, s20, 0
    s_mov_b32 m0, s23
    s_nop 0
    buffer_load_dwordx4 v5, s[4:7], s18 offen lds
    s_add_u32 s23, s20, 1024
    s_mov_b32 m0, s23
    s_nop 0
    buffer_load_dwordx4 v6, s[4:7], s18 offen lds
    s_add_u32 s18, s18, 139264
    buffer_load_dwordx4 v[168:171], v9, s[4:7], s21 offen
    buffer_load_dwordx4 v[172:175], v9, s[4:7], s21 offen offset:1024
    s_add_u32 s21, s21, 2048
    s_add_u32 s23, s20, 8192
    s_mov_b32 m0, s23
    s_nop 0
    buffer_load_dwordx4 v5, s[4:7], s18 offen lds
    s_add_u32 s23, s20, 9216
    s_mov_b32 m0, s23
    s_nop 0
    buffer_load_dwordx4 v6, s[4:7], s18 offen lds
    s_add_u32 s18, s18, 139264
    buffer_load_dwordx4 v[176:179], v9, s[4:7], s21 offen
    buffer_load_dwordx4 v[180:183], v9, s[4:7], s21 offen offset:1024
    s_add_u32 s21, s21, 2048
    s_add_u32 s23, s20, 16384
    s_mov_b32 m0, s23
    s_nop 0
    buffer_load_dwordx4 v5, s[4:7], s18 offen lds
    s_add_u32 s23, s20, 17408
    s_mov_b32 m0, s23
    s_nop 0
    buffer_load_dwordx4 v6, s[4:7], s18 offen lds
    s_add_u32 s18, s18, 139264
    buffer_load_dwordx4 v[184:187], v9, s[4:7], s21 offen
    buffer_load_dwordx4 v[188:191], v9, s[4:7], s21 offen offset:1024
    s_add_u32 s21, s21, 2048
    s_add_u32 s23, s20, 24576
    s_mov_b32 m0, s23
    s_nop 0
    buffer_load_dwordx4 v5, s[4:7], s18 offen lds
    s_add_u32 s23, s20, 25600
    s_mov_b32 m0, s23
    s_nop 0
    buffer_load_dwordx4 v6, s[4:7], s18 offen lds
    s_add_u32 s18, s18, 139264
    buffer_load_dwordx4 v[192:195], v9, s[4:7], s21 offen
    buffer_load_dwordx4 v[196:199], v9, s[4:7], s21 offen offset:1024
    s_add_u32 s21, s21, 2048
    s_add_u32 s23, s20, 32768
    s_mov_b32 m0, s23
    s_nop 0
    buffer_load_dwordx4 v5, s[4:7], s18 offen lds
    s_add_u32 s23, s20, 33792
    s_mov_b32 m0, s23
    s_nop 0
    buffer_load_dwordx4 v6, s[4:7], s18 offen lds
    s_add_u32 s18, s18, 139264
    buffer_load_dwordx4 v[200:203], v9, s[4:7], s21 offen
    buffer_load_dwordx4 v[204:207], v9, s[4:7], s21 offen offset:1024
    s_add_u32 s21, s21, 2048
    buffer_load_dwordx4 v[240:243], v10, s[4:7], s22 offen
    buffer_load_dwordx4 v[244:247], v10, s[4:7], s22 offen offset:64
    s_cmp_gt_u32 s2, 16
    s_cbranch_scc1 L_g1_kernel_nz
    v_mov_b32 v40, 0
    v_lshlrev_b32 v41, 2, v0
    s_lshl_b32 s25, s2, 10
    s_add_u32 s25, s25, 0x900000
    s_cmp_eq_u32 s2, 16
    s_cbranch_scc0 L_g1_kernel_zs
    v_mov_b32 v40, 1
    v_mov_b32 v41, 0
    s_mov_b32 s25, 0x90c000
L_g1_kernel_zs:
    buffer_store_dword v40, v41, s[4:7], s25 offen
    s_waitcnt vmcnt(0)
L_g1_kernel_nz:
    v_lshrrev_b32 v20, 2, v2
    v_and_b32 v21, 3, v2
    v_lshl_add_u32 v22, v3, 2, v20
    v_and_b32 v23, 7, v22
    v_lshlrev_b32 v22, 8, v22
    v_and_b32 v24, 1, v21
    v_lshl_add_u32 v22, v24, 3, v22
    v_lshrrev_b32 v24, 1, v21
    s_lshl_b32 s26, s3, 1
    s_add_u32 s25, s26, 0
    s_and_b32 s25, s25, 7
    v_xor_b32 v25, s25, v23
    v_lshl_add_u32 v25, v25, 1, v24
    v_lshl_add_u32 v12, v25, 4, v22
    s_add_u32 s25, s26, 1
    s_and_b32 s25, s25, 7
    v_xor_b32 v25, s25, v23
    v_lshl_add_u32 v25, v25, 1, v24
    v_lshl_add_u32 v13, v25, 4, v22
    s_add_u32 s25, s26, 2
    s_and_b32 s25, s25, 7
    v_xor_b32 v25, s25, v23
    v_lshl_add_u32 v25, v25, 1, v24
    v_lshl_add_u32 v14, v25, 4, v22
    s_add_u32 s25, s26, 3
    s_and_b32 s25, s25, 7
    v_xor_b32 v25, s25, v23
    v_lshl_add_u32 v25, v25, 1, v24
    v_lshl_add_u32 v15, v25, 4, v22
    s_add_u32 s25, s26, 4
    s_and_b32 s25, s25, 7
    v_xor_b32 v25, s25, v23
    v_lshl_add_u32 v25, v25, 1, v24
    v_lshl_add_u32 v16, v25, 4, v22
    s_add_u32 s25, s26, 5
    s_and_b32 s25, s25, 7
    v_xor_b32 v25, s25, v23
    v_lshl_add_u32 v25, v25, 1, v24
    v_lshl_add_u32 v17, v25, 4, v22
    s_add_u32 s25, s26, 6
    s_and_b32 s25, s25, 7
    v_xor_b32 v25, s25, v23
    v_lshl_add_u32 v25, v25, 1, v24
    v_lshl_add_u32 v18, v25, 4, v22
    s_add_u32 s25, s26, 7
    s_and_b32 s25, s25, 7
    v_xor_b32 v25, s25, v23
    v_lshl_add_u32 v25, v25, 1, v24
    v_lshl_add_u32 v19, v25, 4, v22
    s_mov_b32 s25, 0x3f803f80
    v_mov_b32 v160, s25
    v_mov_b32 v161, s25
    v_mov_b32 v162, s25
    v_mov_b32 v163, s25
    s_waitcnt vmcnt(14)
    s_barrier
    ds_read_b64_tr_b16 v[96:97], v12 offset:0
    ds_read_b64_tr_b16 v[98:99], v12 offset:4096
    ds_read_b64_tr_b16 v[100:101], v13 offset:0
    ds_read_b64_tr_b16 v[102:103], v13 offset:4096
    ds_read_b64_tr_b16 v[104:105], v14 offset:0
    ds_read_b64_tr_b16 v[106:107], v14 offset:4096
    ds_read_b64_tr_b16 v[108:109], v15 offset:0
    ds_read_b64_tr_b16 v[110:111], v15 offset:4096
    ds_read_b64_tr_b16 v[112:113], v16 offset:0
    ds_read_b64_tr_b16 v[114:115], v16 offset:4096
    ds_read_b64_tr_b16 v[116:117], v17 offset:0
    ds_read_b64_tr_b16 v[118:119], v17 offset:4096
    ds_read_b64_tr_b16 v[120:121], v18 offset:0
    ds_read_b64_tr_b16 v[122:123], v18 offset:4096
    ds_read_b64_tr_b16 v[124:125], v19 offset:0
    ds_read_b64_tr_b16 v[126:127], v19 offset:4096
    s_waitcnt lgkmcnt(0)
    v_mfma_f32_16x16x32_bf16 a[0:3], v[168:171], v[96:99], 0
    ds_read_b64_tr_b16 v[128:129], v12 offset:8192
    v_mfma_f32_16x16x32_bf16 a[32:35], v[172:175], v[96:99], 0
    ds_read_b64_tr_b16 v[130:131], v12 offset:12288
    s_add_u32 s23, s20, 40960
    s_mov_b32 m0, s23
    s_nop 0
    buffer_load_dwordx4 v5, s[4:7], s18 offen lds
    v_mfma_f32_16x16x32_bf16 a[4:7], v[168:171], v[100:103], 0
    ds_read_b64_tr_b16 v[132:133], v13 offset:8192
    v_mfma_f32_16x16x32_bf16 a[36:39], v[172:175], v[100:103], 0
    ds_read_b64_tr_b16 v[134:135], v13 offset:12288
    v_mfma_f32_16x16x32_bf16 a[8:11], v[168:171], v[104:107], 0
    ds_read_b64_tr_b16 v[136:137], v14 offset:8192
    v_mfma_f32_16x16x32_bf16 a[40:43], v[172:175], v[104:107], 0
    ds_read_b64_tr_b16 v[138:139], v14 offset:12288
    s_add_u32 s23, s20, 41984
    s_mov_b32 m0, s23
    s_nop 0
    buffer_load_dwordx4 v6, s[4:7], s18 offen lds
    s_add_u32 s18, s18, 139264
    v_mfma_f32_16x16x32_bf16 a[12:15], v[168:171], v[108:111], 0
    ds_read_b64_tr_b16 v[140:141], v15 offset:8192
    v_mfma_f32_16x16x32_bf16 a[44:47], v[172:175], v[108:111], 0
    ds_read_b64_tr_b16 v[142:143], v15 offset:12288
    v_mfma_f32_16x16x32_bf16 a[16:19], v[168:171], v[112:115], 0
    ds_read_b64_tr_b16 v[144:145], v16 offset:8192
    v_mfma_f32_16x16x32_bf16 a[48:51], v[172:175], v[112:115], 0
    ds_read_b64_tr_b16 v[146:147], v16 offset:12288
    buffer_load_dwordx4 v[208:211], v9, s[4:7], s21 offen
    v_mfma_f32_16x16x32_bf16 a[20:23], v[168:171], v[116:119], 0
    ds_read_b64_tr_b16 v[148:149], v17 offset:8192
    v_mfma_f32_16x16x32_bf16 a[52:55], v[172:175], v[116:119], 0
    ds_read_b64_tr_b16 v[150:151], v17 offset:12288
    v_mfma_f32_16x16x32_bf16 a[24:27], v[168:171], v[120:123], 0
    ds_read_b64_tr_b16 v[152:153], v18 offset:8192
    v_mfma_f32_16x16x32_bf16 a[56:59], v[172:175], v[120:123], 0
    ds_read_b64_tr_b16 v[154:155], v18 offset:12288
    buffer_load_dwordx4 v[212:215], v9, s[4:7], s21 offen offset:1024
    s_add_u32 s21, s21, 2048
    v_mfma_f32_16x16x32_bf16 a[28:31], v[168:171], v[124:127], 0
    ds_read_b64_tr_b16 v[156:157], v19 offset:8192
    v_mfma_f32_16x16x32_bf16 a[60:63], v[172:175], v[124:127], 0
    ds_read_b64_tr_b16 v[158:159], v19 offset:12288
    v_mfma_f32_16x16x32_bf16 a[64:67], v[160:163], v[96:99], 0
    v_mfma_f32_16x16x32_bf16 a[72:75], v[96:99], v[96:99], 0
    v_mfma_f32_16x16x32_bf16 a[68:71], v[160:163], v[100:103], 0
    v_mfma_f32_16x16x32_bf16 a[76:79], v[100:103], v[100:103], 0
    s_waitcnt lgkmcnt(0)
    s_waitcnt vmcnt(10)
    s_barrier
    v_mfma_f32_16x16x32_bf16 a[0:3], v[176:179], v[128:131], a[0:3]
    ds_read_b64_tr_b16 v[96:97], v12 offset:16384
    v_mfma_f32_16x16x32_bf16 a[32:35], v[180:183], v[128:131], a[32:35]
    ds_read_b64_tr_b16 v[98:99], v12 offset:20480
    s_add_u32 s23, s20, 49152
    s_mov_b32 m0, s23
    s_nop 0
    buffer_load_dwordx4 v5, s[4:7], s18 offen lds
    v_mfma_f32_16x16x32_bf16 a[4:7], v[176:179], v[132:135], a[4:7]
    ds_read_b64_tr_b16 v[100:101], v13 offset:16384
    v_mfma_f32_16x16x32_bf16 a[36:39], v[180:183], v[132:135], a[36:39]
    ds_read_b64_tr_b16 v[102:103], v13 offset:20480
    v_mfma_f32_16x16x32_bf16 a[8:11], v[176:179], v[136:139], a[8:11]
    ds_read_b64_tr_b16 v[104:105], v14 offset:16384
    v_mfma_f32_16x16x32_bf16 a[40:43], v[180:183], v[136:139], a[40:43]
    ds_read_b64_tr_b16 v[106:107], v14 offset:20480
    s_add_u32 s23, s20, 50176
    s_mov_b32 m0, s23
    s_nop 0
    buffer_load_dwordx4 v6, s[4:7], s18 offen lds
    s_add_u32 s18, s18, 139264
    v_mfma_f32_16x16x32_bf16 a[12:15], v[176:179], v[140:143], a[12:15]
    ds_read_b64_tr_b16 v[108:109], v15 offset:16384
    v_mfma_f32_16x16x32_bf16 a[44:47], v[180:183], v[140:143], a[44:47]
    ds_read_b64_tr_b16 v[110:111], v15 offset:20480
    v_mfma_f32_16x16x32_bf16 a[16:19], v[176:179], v[144:147], a[16:19]
    ds_read_b64_tr_b16 v[112:113], v16 offset:16384
    v_mfma_f32_16x16x32_bf16 a[48:51], v[180:183], v[144:147], a[48:51]
    ds_read_b64_tr_b16 v[114:115], v16 offset:20480
    buffer_load_dwordx4 v[168:171], v9, s[4:7], s21 offen
    v_mfma_f32_16x16x32_bf16 a[20:23], v[176:179], v[148:151], a[20:23]
    ds_read_b64_tr_b16 v[116:117], v17 offset:16384
    v_mfma_f32_16x16x32_bf16 a[52:55], v[180:183], v[148:151], a[52:55]
    ds_read_b64_tr_b16 v[118:119], v17 offset:20480
    v_mfma_f32_16x16x32_bf16 a[24:27], v[176:179], v[152:155], a[24:27]
    ds_read_b64_tr_b16 v[120:121], v18 offset:16384
    v_mfma_f32_16x16x32_bf16 a[56:59], v[180:183], v[152:155], a[56:59]
    ds_read_b64_tr_b16 v[122:123], v18 offset:20480
    buffer_load_dwordx4 v[172:175], v9, s[4:7], s21 offen offset:1024
    s_add_u32 s21, s21, 2048
    v_mfma_f32_16x16x32_bf16 a[28:31], v[176:179], v[156:159], a[28:31]
    ds_read_b64_tr_b16 v[124:125], v19 offset:16384
    v_mfma_f32_16x16x32_bf16 a[60:63], v[180:183], v[156:159], a[60:63]
    ds_read_b64_tr_b16 v[126:127], v19 offset:20480
    v_mfma_f32_16x16x32_bf16 a[64:67], v[160:163], v[128:131], a[64:67]
    v_mfma_f32_16x16x32_bf16 a[72:75], v[128:131], v[128:131], a[72:75]
    v_mfma_f32_16x16x32_bf16 a[68:71], v[160:163], v[132:135], a[68:71]
    v_mfma_f32_16x16x32_bf16 a[76:79], v[132:135], v[132:135], a[76:79]
    s_waitcnt lgkmcnt(0)
    v_mfma_f32_16x16x32_bf16 a[0:3], v[184:187], v[96:99], a[0:3]
    ds_read_b64_tr_b16 v[128:129], v12 offset:24576
    v_mfma_f32_16x16x32_bf16 a[32:35], v[188:191], v[96:99], a[32:35]
    ds_read_b64_tr_b16 v[130:131], v12 offset:28672
    s_add_u32 s23, s20, 57344
    s_mov_b32 m0, s23
    s_nop 0
    buffer_load_dwordx4 v5, s[4:7], s18 offen lds
    v_mfma_f32_16x16x32_bf16 a[4:7], v[184:187], v[100:103], a[4:7]
    ds_read_b64_tr_b16 v[132:133], v13 offset:24576
    v_mfma_f32_16x16x32_bf16 a[36:39], v[188:191], v[100:103], a[36:39]
    ds_read_b64_tr_b16 v[134:135], v13 offset:28672
    v_mfma_f32_16x16x32_bf16 a[8:11], v[184:187], v[104:107], a[8:11]
    ds_read_b64_tr_b16 v[136:137], v14 offset:24576
    v_mfma_f32_16x16x32_bf16 a[40:43], v[188:191], v[104:107], a[40:43]
    ds_read_b64_tr_b16 v[138:139], v14 offset:28672
    s_add_u32 s23, s20, 58368
    s_mov_b32 m0, s23
    s_nop 0
    buffer_load_dwordx4 v6, s[4:7], s18 offen lds
    s_add_u32 s18, s18, 139264
    v_mfma_f32_16x16x32_bf16 a[12:15], v[184:187], v[108:111], a[12:15]
    ds_read_b64_tr_b16 v[140:141], v15 offset:24576
    v_mfma_f32_16x16x32_bf16 a[44:47], v[188:191], v[108:111], a[44:47]
    ds_read_b64_tr_b16 v[142:143], v15 offset:28672
    v_mfma_f32_16x16x32_bf16 a[16:19], v[184:187], v[112:115], a[16:19]
    ds_read_b64_tr_b16 v[144:145], v16 offset:24576
    v_mfma_f32_16x16x32_bf16 a[48:51], v[188:191], v[112:115], a[48:51]
    ds_read_b64_tr_b16 v[146:147], v16 offset:28672
    buffer_load_dwordx4 v[176:179], v9, s[4:7], s21 offen
    v_mfma_f32_16x16x32_bf16 a[20:23], v[184:187], v[116:119], a[20:23]
    ds_read_b64_tr_b16 v[148:149], v17 offset:24576
    v_mfma_f32_16x16x32_bf16 a[52:55], v[188:191], v[116:119], a[52:55]
    ds_read_b64_tr_b16 v[150:151], v17 offset:28672
    v_mfma_f32_16x16x32_bf16 a[24:27], v[184:187], v[120:123], a[24:27]
    ds_read_b64_tr_b16 v[152:153], v18 offset:24576
    v_mfma_f32_16x16x32_bf16 a[56:59], v[188:191], v[120:123], a[56:59]
    ds_read_b64_tr_b16 v[154:155], v18 offset:28672
    buffer_load_dwordx4 v[180:183], v9, s[4:7], s21 offen offset:1024
    s_add_u32 s21, s21, 2048
    v_mfma_f32_16x16x32_bf16 a[28:31], v[184:187], v[124:127], a[28:31]
    ds_read_b64_tr_b16 v[156:157], v19 offset:24576
    v_mfma_f32_16x16x32_bf16 a[60:63], v[188:191], v[124:127], a[60:63]
    ds_read_b64_tr_b16 v[158:159], v19 offset:28672
    v_mfma_f32_16x16x32_bf16 a[64:67], v[160:163], v[96:99], a[64:67]
    v_mfma_f32_16x16x32_bf16 a[72:75], v[96:99], v[96:99], a[72:75]
    v_mfma_f32_16x16x32_bf16 a[68:71], v[160:163], v[100:103], a[68:71]
    v_mfma_f32_16x16x32_bf16 a[76:79], v[100:103], v[100:103], a[76:79]
    s_waitcnt lgkmcnt(0)
    s_waitcnt vmcnt(8)
    s_barrier
    v_mfma_f32_16x16x32_bf16 a[0:3], v[192:195], v[128:131], a[0:3]
    ds_read_b64_tr_b16 v[96:97], v12 offset:32768
    v_mfma_f32_16x16x32_bf16 a[32:35], v[196:199], v[128:131], a[32:35]
    ds_read_b64_tr_b16 v[98:99], v12 offset:36864
    s_add_u32 s23, s20, 65536
    s_mov_b32 m0, s23
    s_nop 0
    buffer_load_dwordx4 v5, s[4:7], s18 offen lds
    v_mfma_f32_16x16x32_bf16 a[4:7], v[192:195], v[132:135], a[4:7]
    ds_read_b64_tr_b16 v[100:101], v13 offset:32768
    v_mfma_f32_16x16x32_bf16 a[36:39], v[196:199], v[132:135], a[36:39]
    ds_read_b64_tr_b16 v[102:103], v13 offset:36864
    v_mfma_f32_16x16x32_bf16 a[8:11], v[192:195], v[136:139], a[8:11]
    ds_read_b64_tr_b16 v[104:105], v14 offset:32768
    v_mfma_f32_16x16x32_bf16 a[40:43], v[196:199], v[136:139], a[40:43]
    ds_read_b64_tr_b16 v[106:107], v14 offset:36864
    s_add_u32 s23, s20, 66560
    s_mov_b32 m0, s23
    s_nop 0
    buffer_load_dwordx4 v6, s[4:7], s18 offen lds
    s_add_u32 s18, s18, 139264
    v_mfma_f32_16x16x32_bf16 a[12:15], v[192:195], v[140:143], a[12:15]
    ds_read_b64_tr_b16 v[108:109], v15 offset:32768
    v_mfma_f32_16x16x32_bf16 a[44:47], v[196:199], v[140:143], a[44:47]
    ds_read_b64_tr_b16 v[110:111], v15 offset:36864
    v_mfma_f32_16x16x32_bf16 a[16:19], v[192:195], v[144:147], a[16:19]
    ds_read_b64_tr_b16 v[112:113], v16 offset:32768
    v_mfma_f32_16x16x32_bf16 a[48:51], v[196:199], v[144:147], a[48:51]
    ds_read_b64_tr_b16 v[114:115], v16 offset:36864
    buffer_load_dwordx4 v[184:187], v9, s[4:7], s21 offen
    v_mfma_f32_16x16x32_bf16 a[20:23], v[192:195], v[148:151], a[20:23]
    ds_read_b64_tr_b16 v[116:117], v17 offset:32768
    v_mfma_f32_16x16x32_bf16 a[52:55], v[196:199], v[148:151], a[52:55]
    ds_read_b64_tr_b16 v[118:119], v17 offset:36864
    v_mfma_f32_16x16x32_bf16 a[24:27], v[192:195], v[152:155], a[24:27]
    ds_read_b64_tr_b16 v[120:121], v18 offset:32768
    v_mfma_f32_16x16x32_bf16 a[56:59], v[196:199], v[152:155], a[56:59]
    ds_read_b64_tr_b16 v[122:123], v18 offset:36864
    buffer_load_dwordx4 v[188:191], v9, s[4:7], s21 offen offset:1024
    s_add_u32 s21, s21, 2048
    v_mfma_f32_16x16x32_bf16 a[28:31], v[192:195], v[156:159], a[28:31]
    ds_read_b64_tr_b16 v[124:125], v19 offset:32768
    v_mfma_f32_16x16x32_bf16 a[60:63], v[196:199], v[156:159], a[60:63]
    ds_read_b64_tr_b16 v[126:127], v19 offset:36864
    v_mfma_f32_16x16x32_bf16 a[64:67], v[160:163], v[128:131], a[64:67]
    v_mfma_f32_16x16x32_bf16 a[72:75], v[128:131], v[128:131], a[72:75]
    v_mfma_f32_16x16x32_bf16 a[68:71], v[160:163], v[132:135], a[68:71]
    v_mfma_f32_16x16x32_bf16 a[76:79], v[132:135], v[132:135], a[76:79]
    s_waitcnt lgkmcnt(0)
    v_mfma_f32_16x16x32_bf16 a[0:3], v[200:203], v[96:99], a[0:3]
    ds_read_b64_tr_b16 v[128:129], v12 offset:40960
    v_mfma_f32_16x16x32_bf16 a[32:35], v[204:207], v[96:99], a[32:35]
    ds_read_b64_tr_b16 v[130:131], v12 offset:45056
    s_add_u32 s23, s20, 73728
    s_mov_b32 m0, s23
    s_nop 0
    buffer_load_dwordx4 v5, s[4:7], s18 offen lds
    v_mfma_f32_16x16x32_bf16 a[4:7], v[200:203], v[100:103], a[4:7]
    ds_read_b64_tr_b16 v[132:133], v13 offset:40960
    v_mfma_f32_16x16x32_bf16 a[36:39], v[204:207], v[100:103], a[36:39]
    ds_read_b64_tr_b16 v[134:135], v13 offset:45056
    v_mfma_f32_16x16x32_bf16 a[8:11], v[200:203], v[104:107], a[8:11]
    ds_read_b64_tr_b16 v[136:137], v14 offset:40960
    v_mfma_f32_16x16x32_bf16 a[40:43], v[204:207], v[104:107], a[40:43]
    ds_read_b64_tr_b16 v[138:139], v14 offset:45056
    s_add_u32 s23, s20, 74752
    s_mov_b32 m0, s23
    s_nop 0
    buffer_load_dwordx4 v6, s[4:7], s18 offen lds
    s_add_u32 s18, s18, 139264
    v_mfma_f32_16x16x32_bf16 a[12:15], v[200:203], v[108:111], a[12:15]
    ds_read_b64_tr_b16 v[140:141], v15 offset:40960
    v_mfma_f32_16x16x32_bf16 a[44:47], v[204:207], v[108:111], a[44:47]
    ds_read_b64_tr_b16 v[142:143], v15 offset:45056
    v_mfma_f32_16x16x32_bf16 a[16:19], v[200:203], v[112:115], a[16:19]
    ds_read_b64_tr_b16 v[144:145], v16 offset:40960
    v_mfma_f32_16x16x32_bf16 a[48:51], v[204:207], v[112:115], a[48:51]
    ds_read_b64_tr_b16 v[146:147], v16 offset:45056
    buffer_load_dwordx4 v[192:195], v9, s[4:7], s21 offen
    v_mfma_f32_16x16x32_bf16 a[20:23], v[200:203], v[116:119], a[20:23]
    ds_read_b64_tr_b16 v[148:149], v17 offset:40960
    v_mfma_f32_16x16x32_bf16 a[52:55], v[204:207], v[116:119], a[52:55]
    ds_read_b64_tr_b16 v[150:151], v17 offset:45056
    v_mfma_f32_16x16x32_bf16 a[24:27], v[200:203], v[120:123], a[24:27]
    ds_read_b64_tr_b16 v[152:153], v18 offset:40960
    v_mfma_f32_16x16x32_bf16 a[56:59], v[204:207], v[120:123], a[56:59]
    ds_read_b64_tr_b16 v[154:155], v18 offset:45056
    buffer_load_dwordx4 v[196:199], v9, s[4:7], s21 offen offset:1024
    s_add_u32 s21, s21, 2048
    v_mfma_f32_16x16x32_bf16 a[28:31], v[200:203], v[124:127], a[28:31]
    ds_read_b64_tr_b16 v[156:157], v19 offset:40960
    v_mfma_f32_16x16x32_bf16 a[60:63], v[204:207], v[124:127], a[60:63]
    ds_read_b64_tr_b16 v[158:159], v19 offset:45056
    v_mfma_f32_16x16x32_bf16 a[64:67], v[160:163], v[96:99], a[64:67]
    v_mfma_f32_16x16x32_bf16 a[72:75], v[96:99], v[96:99], a[72:75]
    v_mfma_f32_16x16x32_bf16 a[68:71], v[160:163], v[100:103], a[68:71]
    v_mfma_f32_16x16x32_bf16 a[76:79], v[100:103], v[100:103], a[76:79]
    s_waitcnt lgkmcnt(0)
    s_waitcnt vmcnt(8)
    s_barrier
    v_mfma_f32_16x16x32_bf16 a[0:3], v[208:211], v[128:131], a[0:3]
    ds_read_b64_tr_b16 v[96:97], v12 offset:49152
    v_mfma_f32_16x16x32_bf16 a[32:35], v[212:215], v[128:131], a[32:35]
    ds_read_b64_tr_b16 v[98:99], v12 offset:53248
    s_add_u32 s23, s20, 81920
    s_mov_b32 m0, s23
    s_nop 0
    buffer_load_dwordx4 v5, s[4:7], s18 offen lds
    v_mfma_f32_16x16x32_bf16 a[4:7], v[208:211], v[132:135], a[4:7]
    ds_read_b64_tr_b16 v[100:101], v13 offset:49152
    v_mfma_f32_16x16x32_bf16 a[36:39], v[212:215], v[132:135], a[36:39]
    ds_read_b64_tr_b16 v[102:103], v13 offset:53248
    v_mfma_f32_16x16x32_bf16 a[8:11], v[208:211], v[136:139], a[8:11]
    ds_read_b64_tr_b16 v[104:105], v14 offset:49152
    v_mfma_f32_16x16x32_bf16 a[40:43], v[212:215], v[136:139], a[40:43]
    ds_read_b64_tr_b16 v[106:107], v14 offset:53248
    s_add_u32 s23, s20, 82944
    s_mov_b32 m0, s23
    s_nop 0
    buffer_load_dwordx4 v6, s[4:7], s18 offen lds
    s_add_u32 s18, s18, 139264
    v_mfma_f32_16x16x32_bf16 a[12:15], v[208:211], v[140:143], a[12:15]
    ds_read_b64_tr_b16 v[108:109], v15 offset:49152
    v_mfma_f32_16x16x32_bf16 a[44:47], v[212:215], v[140:143], a[44:47]
    ds_read_b64_tr_b16 v[110:111], v15 offset:53248
    v_mfma_f32_16x16x32_bf16 a[16:19], v[208:211], v[144:147], a[16:19]
    ds_read_b64_tr_b16 v[112:113], v16 offset:49152
    v_mfma_f32_16x16x32_bf16 a[48:51], v[212:215], v[144:147], a[48:51]
    ds_read_b64_tr_b16 v[114:115], v16 offset:53248
    buffer_load_dwordx4 v[200:203], v9, s[4:7], s21 offen
    v_mfma_f32_16x16x32_bf16 a[20:23], v[208:211], v[148:151], a[20:23]
    ds_read_b64_tr_b16 v[116:117], v17 offset:49152
    v_mfma_f32_16x16x32_bf16 a[52:55], v[212:215], v[148:151], a[52:55]
    ds_read_b64_tr_b16 v[118:119], v17 offset:53248
    v_mfma_f32_16x16x32_bf16 a[24:27], v[208:211], v[152:155], a[24:27]
    ds_read_b64_tr_b16 v[120:121], v18 offset:49152
    v_mfma_f32_16x16x32_bf16 a[56:59], v[212:215], v[152:155], a[56:59]
    ds_read_b64_tr_b16 v[122:123], v18 offset:53248
    buffer_load_dwordx4 v[204:207], v9, s[4:7], s21 offen offset:1024
    s_add_u32 s21, s21, 2048
    v_mfma_f32_16x16x32_bf16 a[28:31], v[208:211], v[156:159], a[28:31]
    ds_read_b64_tr_b16 v[124:125], v19 offset:49152
    v_mfma_f32_16x16x32_bf16 a[60:63], v[212:215], v[156:159], a[60:63]
    ds_read_b64_tr_b16 v[126:127], v19 offset:53248
    v_mfma_f32_16x16x32_bf16 a[64:67], v[160:163], v[128:131], a[64:67]
    v_mfma_f32_16x16x32_bf16 a[72:75], v[128:131], v[128:131], a[72:75]
    v_mfma_f32_16x16x32_bf16 a[68:71], v[160:163], v[132:135], a[68:71]
    v_mfma_f32_16x16x32_bf16 a[76:79], v[132:135], v[132:135], a[76:79]
    s_waitcnt lgkmcnt(0)
    v_mfma_f32_16x16x32_bf16 a[0:3], v[168:171], v[96:99], a[0:3]
    ds_read_b64_tr_b16 v[128:129], v12 offset:57344
    v_mfma_f32_16x16x32_bf16 a[32:35], v[172:175], v[96:99], a[32:35]
    ds_read_b64_tr_b16 v[130:131], v12 offset:61440
    s_add_u32 s23, s20, 90112
    s_mov_b32 m0, s23
    s_nop 0
    buffer_load_dwordx4 v5, s[4:7], s18 offen lds
    v_mfma_f32_16x16x32_bf16 a[4:7], v[168:171], v[100:103], a[4:7]
    ds_read_b64_tr_b16 v[132:133], v13 offset:57344
    v_mfma_f32_16x16x32_bf16 a[36:39], v[172:175], v[100:103], a[36:39]
    ds_read_b64_tr_b16 v[134:135], v13 offset:61440
    v_mfma_f32_16x16x32_bf16 a[8:11], v[168:171], v[104:107], a[8:11]
    ds_read_b64_tr_b16 v[136:137], v14 offset:57344
    v_mfma_f32_16x16x32_bf16 a[40:43], v[172:175], v[104:107], a[40:43]
    ds_read_b64_tr_b16 v[138:139], v14 offset:61440
    s_add_u32 s23, s20, 91136
    s_mov_b32 m0, s23
    s_nop 0
    buffer_load_dwordx4 v6, s[4:7], s18 offen lds
    s_add_u32 s18, s18, 139264
    v_mfma_f32_16x16x32_bf16 a[12:15], v[168:171], v[108:111], a[12:15]
    ds_read_b64_tr_b16 v[140:141], v15 offset:57344
    v_mfma_f32_16x16x32_bf16 a[44:47], v[172:175], v[108:111], a[44:47]
    ds_read_b64_tr_b16 v[142:143], v15 offset:61440
    v_mfma_f32_16x16x32_bf16 a[16:19], v[168:171], v[112:115], a[16:19]
    ds_read_b64_tr_b16 v[144:145], v16 offset:57344
    v_mfma_f32_16x16x32_bf16 a[48:51], v[172:175], v[112:115], a[48:51]
    ds_read_b64_tr_b16 v[146:147], v16 offset:61440
    buffer_load_dwordx4 v[208:211], v9, s[4:7], s21 offen
    v_mfma_f32_16x16x32_bf16 a[20:23], v[168:171], v[116:119], a[20:23]
    ds_read_b64_tr_b16 v[148:149], v17 offset:57344
    v_mfma_f32_16x16x32_bf16 a[52:55], v[172:175], v[116:119], a[52:55]
    ds_read_b64_tr_b16 v[150:151], v17 offset:61440
    v_mfma_f32_16x16x32_bf16 a[24:27], v[168:171], v[120:123], a[24:27]
    ds_read_b64_tr_b16 v[152:153], v18 offset:57344
    v_mfma_f32_16x16x32_bf16 a[56:59], v[172:175], v[120:123], a[56:59]
    ds_read_b64_tr_b16 v[154:155], v18 offset:61440
    buffer_load_dwordx4 v[212:215], v9, s[4:7], s21 offen offset:1024
    s_add_u32 s21, s21, 2048
    v_mfma_f32_16x16x32_bf16 a[28:31], v[168:171], v[124:127], a[28:31]
    ds_read_b64_tr_b16 v[156:157], v19 offset:57344
    v_mfma_f32_16x16x32_bf16 a[60:63], v[172:175], v[124:127], a[60:63]
    ds_read_b64_tr_b16 v[158:159], v19 offset:61440
    v_mfma_f32_16x16x32_bf16 a[64:67], v[160:163], v[96:99], a[64:67]
    v_mfma_f32_16x16x32_bf16 a[72:75], v[96:99], v[96:99], a[72:75]
    v_mfma_f32_16x16x32_bf16 a[68:71], v[160:163], v[100:103], a[68:71]
    v_mfma_f32_16x16x32_bf16 a[76:79], v[100:103], v[100:103], a[76:79]
    s_waitcnt lgkmcnt(0)
    s_waitcnt vmcnt(8)
    s_barrier
    v_mfma_f32_16x16x32_bf16 a[0:3], v[176:179], v[128:131], a[0:3]
    v_add_u32 v12, 0x10000, v12
    v_add_u32 v13, 0x10000, v13
    v_add_u32 v14, 0x10000, v14
    v_add_u32 v15, 0x10000, v15
    v_add_u32 v16, 0x10000, v16
    v_add_u32 v17, 0x10000, v17
    v_add_u32 v18, 0x10000, v18
    v_add_u32 v19, 0x10000, v19
    v_mfma_f32_16x16x32_bf16 a[32:35], v[180:183], v[128:131], a[32:35]
    ds_read_b64_tr_b16 v[96:97], v12 offset:0
    s_add_u32 s23, s20, 98304
    s_mov_b32 m0, s23
    s_nop 0
    buffer_load_dwordx4 v5, s[4:7], s18 offen lds
    v_mfma_f32_16x16x32_bf16 a[4:7], v[176:179], v[132:135], a[4:7]
    ds_read_b64_tr_b16 v[98:99], v12 offset:4096
    v_mfma_f32_16x16x32_bf16 a[36:39], v[180:183], v[132:135], a[36:39]
    ds_read_b64_tr_b16 v[100:101], v13 offset:0
    v_mfma_f32_16x16x32_bf16 a[8:11], v[176:179], v[136:139], a[8:11]
    ds_read_b64_tr_b16 v[102:103], v13 offset:4096
    v_mfma_f32_16x16x32_bf16 a[40:43], v[180:183], v[136:139], a[40:43]
    ds_read_b64_tr_b16 v[104:105], v14 offset:0
    s_add_u32 s23, s20, 99328
    s_mov_b32 m0, s23
    s_nop 0
    buffer_load_dwordx4 v6, s[4:7], s18 offen lds
    s_add_u32 s18, s18, 139264
    v_mfma_f32_16x16x32_bf16 a[12:15], v[176:179], v[140:143], a[12:15]
    ds_read_b64_tr_b16 v[106:107], v14 offset:4096
    v_mfma_f32_16x16x32_bf16 a[44:47], v[180:183], v[140:143], a[44:47]
    ds_read_b64_tr_b16 v[108:109], v15 offset:0
    v_mfma_f32_16x16x32_bf16 a[16:19], v[176:179], v[144:147], a[16:19]
    ds_read_b64_tr_b16 v[110:111], v15 offset:4096
    v_mfma_f32_16x16x32_bf16 a[48:51], v[180:183], v[144:147], a[48:51]
    ds_read_b64_tr_b16 v[112:113], v16 offset:0
    buffer_load_dwordx4 v[168:171], v9, s[4:7], s21 offen
    v_mfma_f32_16x16x32_bf16 a[20:23], v[176:179], v[148:151], a[20:23]
    ds_read_b64_tr_b16 v[114:115], v16 offset:4096
    v_mfma_f32_16x16x32_bf16 a[52:55], v[180:183], v[148:151], a[52:55]
    ds_read_b64_tr_b16 v[116:117], v17 offset:0
    v_mfma_f32_16x16x32_bf16 a[24:27], v[176:179], v[152:155], a[24:27]
    ds_read_b64_tr_b16 v[118:119], v17 offset:4096
    v_mfma_f32_16x16x32_bf16 a[56:59], v[180:183], v[152:155], a[56:59]
    ds_read_b64_tr_b16 v[120:121], v18 offset:0
    buffer_load_dwordx4 v[172:175], v9, s[4:7], s21 offen offset:1024
    s_add_u32 s21, s21, 2048
    v_mfma_f32_16x16x32_bf16 a[28:31], v[176:179], v[156:159], a[28:31]
    ds_read_b64_tr_b16 v[122:123], v18 offset:4096
    v_mfma_f32_16x16x32_bf16 a[60:63], v[180:183], v[156:159], a[60:63]
    ds_read_b64_tr_b16 v[124:125], v19 offset:0
    v_mfma_f32_16x16x32_bf16 a[64:67], v[160:163], v[128:131], a[64:67]
    ds_read_b64_tr_b16 v[126:127], v19 offset:4096
    v_mfma_f32_16x16x32_bf16 a[72:75], v[128:131], v[128:131], a[72:75]
    v_mfma_f32_16x16x32_bf16 a[68:71], v[160:163], v[132:135], a[68:71]
    v_mfma_f32_16x16x32_bf16 a[76:79], v[132:135], v[132:135], a[76:79]
    s_waitcnt lgkmcnt(0)
    v_mfma_f32_16x16x32_bf16 a[0:3], v[184:187], v[96:99], a[0:3]
    ds_read_b64_tr_b16 v[128:129], v12 offset:8192
    v_mfma_f32_16x16x32_bf16 a[32:35], v[188:191], v[96:99], a[32:35]
    ds_read_b64_tr_b16 v[130:131], v12 offset:12288
    s_add_u32 s23, s20, 106496
    s_mov_b32 m0, s23
    s_nop 0
    buffer_load_dwordx4 v5, s[4:7], s18 offen lds
    v_mfma_f32_16x16x32_bf16 a[4:7], v[184:187], v[100:103], a[4:7]
    ds_read_b64_tr_b16 v[132:133], v13 offset:8192
    v_mfma_f32_16x16x32_bf16 a[36:39], v[188:191], v[100:103], a[36:39]
    ds_read_b64_tr_b16 v[134:135], v13 offset:12288
    v_mfma_f32_16x16x32_bf16 a[8:11], v[184:187], v[104:107], a[8:11]
    ds_read_b64_tr_b16 v[136:137], v14 offset:8192
    v_mfma_f32_16x16x32_bf16 a[40:43], v[188:191], v[104:107], a[40:43]
    ds_read_b64_tr_b16 v[138:139], v14 offset:12288
    s_add_u32 s23, s20, 107520
    s_mov_b32 m0, s23
    s_nop 0
    buffer_load_dwordx4 v6, s[4:7], s18 offen lds
    s_add_u32 s18, s18, 139264
    v_mfma_f32_16x16x32_bf16 a[12:15], v[184:187], v[108:111], a[12:15]
    ds_read_b64_tr_b16 v[140:141], v15 offset:8192
    v_mfma_f32_16x16x32_bf16 a[44:47], v[188:191], v[108:111], a[44:47]
    ds_read_b64_tr_b16 v[142:143], v15 offset:12288
    v_mfma_f32_16x16x32_bf16 a[16:19], v[184:187], v[112:115], a[16:19]
    ds_read_b64_tr_b16 v[144:145], v16 offset:8192
    v_mfma_f32_16x16x32_bf16 a[48:51], v[188:191], v[112:115], a[48:51]
    ds_read_b64_tr_b16 v[146:147], v16 offset:12288
    buffer_load_dwordx4 v[176:179], v9, s[4:7], s21 offen
    v_mfma_f32_16x16x32_bf16 a[20:23], v[184:187], v[116:119], a[20:23]
    ds_read_b64_tr_b16 v[148:149], v17 offset:8192
    v_mfma_f32_16x16x32_bf16 a[52:55], v[188:191], v[116:119], a[52:55]
    ds_read_b64_tr_b16 v[150:151], v17 offset:12288
    v_mfma_f32_16x16x32_bf16 a[24:27], v[184:187], v[120:123], a[24:27]
    ds_read_b64_tr_b16 v[152:153], v18 offset:8192
    v_mfma_f32_16x16x32_bf16 a[56:59], v[188:191], v[120:123], a[56:59]
    ds_read_b64_tr_b16 v[154:155], v18 offset:12288
    buffer_load_dwordx4 v[180:183], v9, s[4:7], s21 offen offset:1024
    s_add_u32 s21, s21, 2048
    v_mfma_f32_16x16x32_bf16 a[28:31], v[184:187], v[124:127], a[28:31]
    ds_read_b64_tr_b16 v[156:157], v19 offset:8192
    v_mfma_f32_16x16x32_bf16 a[60:63], v[188:191], v[124:127], a[60:63]
    ds_read_b64_tr_b16 v[158:159], v19 offset:12288
    v_mfma_f32_16x16x32_bf16 a[64:67], v[160:163], v[96:99], a[64:67]
    v_mfma_f32_16x16x32_bf16 a[72:75], v[96:99], v[96:99], a[72:75]
    v_mfma_f32_16x16x32_bf16 a[68:71], v[160:163], v[100:103], a[68:71]
    v_mfma_f32_16x16x32_bf16 a[76:79], v[100:103], v[100:103], a[76:79]
    s_waitcnt lgkmcnt(0)
    s_waitcnt vmcnt(8)
    s_barrier
    v_mfma_f32_16x16x32_bf16 a[0:3], v[192:195], v[128:131], a[0:3]
    ds_read_b64_tr_b16 v[96:97], v12 offset:16384
    v_mfma_f32_16x16x32_bf16 a[32:35], v[196:199], v[128:131], a[32:35]
    ds_read_b64_tr_b16 v[98:99], v12 offset:20480
    s_add_u32 s23, s20, 114688
    s_mov_b32 m0, s23
    s_nop 0
    buffer_load_dwordx4 v5, s[4:7], s18 offen lds
    v_mfma_f32_16x16x32_bf16 a[4:7], v[192:195], v[132:135], a[4:7]
    ds_read_b64_tr_b16 v[100:101], v13 offset:16384
    v_mfma_f32_16x16x32_bf16 a[36:39], v[196:199], v[132:135], a[36:39]
    ds_read_b64_tr_b16 v[102:103], v13 offset:20480
    v_mfma_f32_16x16x32_bf16 a[8:11], v[192:195], v[136:139], a[8:11]
    ds_read_b64_tr_b16 v[104:105], v14 offset:16384
    v_mfma_f32_16x16x32_bf16 a[40:43], v[196:199], v[136:139], a[40:43]
    ds_read_b64_tr_b16 v[106:107], v14 offset:20480
    s_add_u32 s23, s20, 115712
    s_mov_b32 m0, s23
    s_nop 0
    buffer_load_dwordx4 v6, s[4:7], s18 offen lds
    s_add_u32 s18, s18, 139264
    v_mfma_f32_16x16x32_bf16 a[12:15], v[192:195], v[140:143], a[12:15]
    ds_read_b64_tr_b16 v[108:109], v15 offset:16384
    v_mfma_f32_16x16x32_bf16 a[44:47], v[196:199], v[140:143], a[44:47]
    ds_read_b64_tr_b16 v[110:111], v15 offset:20480
    v_mfma_f32_16x16x32_bf16 a[16:19], v[192:195], v[144:147], a[16:19]
    ds_read_b64_tr_b16 v[112:113], v16 offset:16384
    v_mfma_f32_16x16x32_bf16 a[48:51], v[196:199], v[144:147], a[48:51]
    ds_read_b64_tr_b16 v[114:115], v16 offset:20480
    buffer_load_dwordx4 v[184:187], v9, s[4:7], s21 offen
    v_mfma_f32_16x16x32_bf16 a[20:23], v[192:195], v[148:151], a[20:23]
    ds_read_b64_tr_b16 v[116:117], v17 offset:16384
    v_mfma_f32_16x16x32_bf16 a[52:55], v[196:199], v[148:151], a[52:55]
    ds_read_b64_tr_b16 v[118:119], v17 offset:20480
    v_mfma_f32_16x16x32_bf16 a[24:27], v[192:195], v[152:155], a[24:27]
    ds_read_b64_tr_b16 v[120:121], v18 offset:16384
    v_mfma_f32_16x16x32_bf16 a[56:59], v[196:199], v[152:155], a[56:59]
    ds_read_b64_tr_b16 v[122:123], v18 offset:20480
    buffer_load_dwordx4 v[188:191], v9, s[4:7], s21 offen offset:1024
    s_add_u32 s21, s21, 2048
    v_mfma_f32_16x16x32_bf16 a[28:31], v[192:195], v[156:159], a[28:31]
    ds_read_b64_tr_b16 v[124:125], v19 offset:16384
    v_mfma_f32_16x16x32_bf16 a[60:63], v[196:199], v[156:159], a[60:63]
    ds_read_b64_tr_b16 v[126:127], v19 offset:20480
    v_mfma_f32_16x16x32_bf16 a[64:67], v[160:163], v[128:131], a[64:67]
    v_mfma_f32_16x16x32_bf16 a[72:75], v[128:131], v[128:131], a[72:75]
    v_mfma_f32_16x16x32_bf16 a[68:71], v[160:163], v[132:135], a[68:71]
    v_mfma_f32_16x16x32_bf16 a[76:79], v[132:135], v[132:135], a[76:79]
    s_waitcnt lgkmcnt(0)
    v_mfma_f32_16x16x32_bf16 a[0:3], v[200:203], v[96:99], a[0:3]
    ds_read_b64_tr_b16 v[128:129], v12 offset:24576
    v_mfma_f32_16x16x32_bf16 a[32:35], v[204:207], v[96:99], a[32:35]
    ds_read_b64_tr_b16 v[130:131], v12 offset:28672
    s_add_u32 s23, s20, 122880
    s_mov_b32 m0, s23
    s_nop 0
    buffer_load_dwordx4 v5, s[4:7], s18 offen lds
    v_mfma_f32_16x16x32_bf16 a[4:7], v[200:203], v[100:103], a[4:7]
    ds_read_b64_tr_b16 v[132:133], v13 offset:24576
    v_mfma_f32_16x16x32_bf16 a[36:39], v[204:207], v[100:103], a[36:39]
    ds_read_b64_tr_b16 v[134:135], v13 offset:28672
    v_mfma_f32_16x16x32_bf16 a[8:11], v[200:203], v[104:107], a[8:11]
    ds_read_b64_tr_b16 v[136:137], v14 offset:24576
    v_mfma_f32_16x16x32_bf16 a[40:43], v[204:207], v[104:107], a[40:43]
    ds_read_b64_tr_b16 v[138:139], v14 offset:28672
    s_add_u32 s23, s20, 123904
    s_mov_b32 m0, s23
    s_nop 0
    buffer_load_dwordx4 v6, s[4:7], s18 offen lds
    s_add_u32 s18, s18, 139264
    v_mfma_f32_16x16x32_bf16 a[12:15], v[200:203], v[108:111], a[12:15]
    ds_read_b64_tr_b16 v[140:141], v15 offset:24576
    v_mfma_f32_16x16x32_bf16 a[44:47], v[204:207], v[108:111], a[44:47]
    ds_read_b64_tr_b16 v[142:143], v15 offset:28672
    v_mfma_f32_16x16x32_bf16 a[16:19], v[200:203], v[112:115], a[16:19]
    ds_read_b64_tr_b16 v[144:145], v16 offset:24576
    v_mfma_f32_16x16x32_bf16 a[48:51], v[204:207], v[112:115], a[48:51]
    ds_read_b64_tr_b16 v[146:147], v16 offset:28672
    buffer_load_dwordx4 v[192:195], v9, s[4:7], s21 offen
    v_mfma_f32_16x16x32_bf16 a[20:23], v[200:203], v[116:119], a[20:23]
    ds_read_b64_tr_b16 v[148:149], v17 offset:24576
    v_mfma_f32_16x16x32_bf16 a[52:55], v[204:207], v[116:119], a[52:55]
    ds_read_b64_tr_b16 v[150:151], v17 offset:28672
    v_mfma_f32_16x16x32_bf16 a[24:27], v[200:203], v[120:123], a[24:27]
    ds_read_b64_tr_b16 v[152:153], v18 offset:24576
    v_mfma_f32_16x16x32_bf16 a[56:59], v[204:207], v[120:123], a[56:59]
    ds_read_b64_tr_b16 v[154:155], v18 offset:28672
    buffer_load_dwordx4 v[196:199], v9, s[4:7], s21 offen offset:1024
    s_add_u32 s21, s21, 2048
    v_mfma_f32_16x16x32_bf16 a[28:31], v[200:203], v[124:127], a[28:31]
    ds_read_b64_tr_b16 v[156:157], v19 offset:24576
    v_mfma_f32_16x16x32_bf16 a[60:63], v[204:207], v[124:127], a[60:63]
    ds_read_b64_tr_b16 v[158:159], v19 offset:28672
    v_mfma_f32_16x16x32_bf16 a[64:67], v[160:163], v[96:99], a[64:67]
    v_mfma_f32_16x16x32_bf16 a[72:75], v[96:99], v[96:99], a[72:75]
    v_mfma_f32_16x16x32_bf16 a[68:71], v[160:163], v[100:103], a[68:71]
    v_mfma_f32_16x16x32_bf16 a[76:79], v[100:103], v[100:103], a[76:79]
    s_waitcnt lgkmcnt(0)
    s_waitcnt vmcnt(8)
    s_barrier
    v_mfma_f32_16x16x32_bf16 a[0:3], v[208:211], v[128:131], a[0:3]
    ds_read_b64_tr_b16 v[96:97], v12 offset:32768
    v_mfma_f32_16x16x32_bf16 a[32:35], v[212:215], v[128:131], a[32:35]
    ds_read_b64_tr_b16 v[98:99], v12 offset:36864
    v_mfma_f32_16x16x32_bf16 a[4:7], v[208:211], v[132:135], a[4:7]
    ds_read_b64_tr_b16 v[100:101], v13 offset:32768
    v_mfma_f32_16x16x32_bf16 a[36:39], v[212:215], v[132:135], a[36:39]
    ds_read_b64_tr_b16 v[102:103], v13 offset:36864
    v_mfma_f32_16x16x32_bf16 a[8:11], v[208:211], v[136:139], a[8:11]
    ds_read_b64_tr_b16 v[104:105], v14 offset:32768
    v_mfma_f32_16x16x32_bf16 a[40:43], v[212:215], v[136:139], a[40:43]
    ds_read_b64_tr_b16 v[106:107], v14 offset:36864
    v_mfma_f32_16x16x32_bf16 a[12:15], v[208:211], v[140:143], a[12:15]
    ds_read_b64_tr_b16 v[108:109], v15 offset:32768
    v_mfma_f32_16x16x32_bf16 a[44:47], v[212:215], v[140:143], a[44:47]
    ds_read_b64_tr_b16 v[110:111], v15 offset:36864
    v_mfma_f32_16x16x32_bf16 a[16:19], v[208:211], v[144:147], a[16:19]
    ds_read_b64_tr_b16 v[112:113], v16 offset:32768
    v_mfma_f32_16x16x32_bf16 a[48:51], v[212:215], v[144:147], a[48:51]
    ds_read_b64_tr_b16 v[114:115], v16 offset:36864
    v_mfma_f32_16x16x32_bf16 a[20:23], v[208:211], v[148:151], a[20:23]
    ds_read_b64_tr_b16 v[116:117], v17 offset:32768
    v_mfma_f32_16x16x32_bf16 a[52:55], v[212:215], v[148:151], a[52:55]
    ds_read_b64_tr_b16 v[118:119], v17 offset:36864
    v_mfma_f32_16x16x32_bf16 a[24:27], v[208:211], v[152:155], a[24:27]
    ds_read_b64_tr_b16 v[120:121], v18 offset:32768
    v_mfma_f32_16x16x32_bf16 a[56:59], v[212:215], v[152:155], a[56:59]
    ds_read_b64_tr_b16 v[122:123], v18 offset:36864
    v_mfma_f32_16x16x32_bf16 a[28:31], v[208:211], v[156:159], a[28:31]
    ds_read_b64_tr_b16 v[124:125], v19 offset:32768
    v_mfma_f32_16x16x32_bf16 a[60:63], v[212:215], v[156:159], a[60:63]
    ds_read_b64_tr_b16 v[126:127], v19 offset:36864
    v_mfma_f32_16x16x32_bf16 a[64:67], v[160:163], v[128:131], a[64:67]
    v_mfma_f32_16x16x32_bf16 a[72:75], v[128:131], v[128:131], a[72:75]
    v_mfma_f32_16x16x32_bf16 a[68:71], v[160:163], v[132:135], a[68:71]
    v_mfma_f32_16x16x32_bf16 a[76:79], v[132:135], v[132:135], a[76:79]
    s_waitcnt lgkmcnt(0)
    v_mfma_f32_16x16x32_bf16 a[0:3], v[168:171], v[96:99], a[0:3]
    ds_read_b64_tr_b16 v[128:129], v12 offset:40960
    v_mfma_f32_16x16x32_bf16 a[32:35], v[172:175], v[96:99], a[32:35]
    ds_read_b64_tr_b16 v[130:131], v12 offset:45056
    v_mfma_f32_16x16x32_bf16 a[4:7], v[168:171], v[100:103], a[4:7]
    ds_read_b64_tr_b16 v[132:133], v13 offset:40960
    v_mfma_f32_16x16x32_bf16 a[36:39], v[172:175], v[100:103], a[36:39]
    ds_read_b64_tr_b16 v[134:135], v13 offset:45056
    v_mfma_f32_16x16x32_bf16 a[8:11], v[168:171], v[104:107], a[8:11]
    ds_read_b64_tr_b16 v[136:137], v14 offset:40960
    v_mfma_f32_16x16x32_bf16 a[40:43], v[172:175], v[104:107], a[40:43]
    ds_read_b64_tr_b16 v[138:139], v14 offset:45056
    v_mfma_f32_16x16x32_bf16 a[12:15], v[168:171], v[108:111], a[12:15]
    ds_read_b64_tr_b16 v[140:141], v15 offset:40960
    v_mfma_f32_16x16x32_bf16 a[44:47], v[172:175], v[108:111], a[44:47]
    ds_read_b64_tr_b16 v[142:143], v15 offset:45056
    v_mfma_f32_16x16x32_bf16 a[16:19], v[168:171], v[112:115], a[16:19]
    ds_read_b64_tr_b16 v[144:145], v16 offset:40960
    v_mfma_f32_16x16x32_bf16 a[48:51], v[172:175], v[112:115], a[48:51]
    ds_read_b64_tr_b16 v[146:147], v16 offset:45056
    v_mfma_f32_16x16x32_bf16 a[20:23], v[168:171], v[116:119], a[20:23]
    ds_read_b64_tr_b16 v[148:149], v17 offset:40960
    v_mfma_f32_16x16x32_bf16 a[52:55], v[172:175], v[116:119], a[52:55]
    ds_read_b64_tr_b16 v[150:151], v17 offset:45056
    v_mfma_f32_16x16x32_bf16 a[24:27], v[168:171], v[120:123], a[24:27]
    ds_read_b64_tr_b16 v[152:153], v18 offset:40960
    v_mfma_f32_16x16x32_bf16 a[56:59], v[172:175], v[120:123], a[56:59]
    ds_read_b64_tr_b16 v[154:155], v18 offset:45056
    v_mfma_f32_16x16x32_bf16 a[28:31], v[168:171], v[124:127], a[28:31]
    ds_read_b64_tr_b16 v[156:157], v19 offset:40960
    v_mfma_f32_16x16x32_bf16 a[60:63], v[172:175], v[124:127], a[60:63]
    ds_read_b64_tr_b16 v[158:159], v19 offset:45056
    v_mfma_f32_16x16x32_bf16 a[64:67], v[160:163], v[96:99], a[64:67]
    v_mfma_f32_16x16x32_bf16 a[72:75], v[96:99], v[96:99], a[72:75]
    v_mfma_f32_16x16x32_bf16 a[68:71], v[160:163], v[100:103], a[68:71]
    v_mfma_f32_16x16x32_bf16 a[76:79], v[100:103], v[100:103], a[76:79]
    s_waitcnt lgkmcnt(0)
    s_waitcnt vmcnt(0)
    s_barrier
    v_mfma_f32_16x16x32_bf16 a[0:3], v[176:179], v[128:131], a[0:3]
    ds_read_b64_tr_b16 v[96:97], v12 offset:49152
    v_mfma_f32_16x16x32_bf16 a[32:35], v[180:183], v[128:131], a[32:35]
    ds_read_b64_tr_b16 v[98:99], v12 offset:53248
    v_mfma_f32_16x16x32_bf16 a[4:7], v[176:179], v[132:135], a[4:7]
    ds_read_b64_tr_b16 v[100:101], v13 offset:49152
    v_mfma_f32_16x16x32_bf16 a[36:39], v[180:183], v[132:135], a[36:39]
    ds_read_b64_tr_b16 v[102:103], v13 offset:53248
    v_mfma_f32_16x16x32_bf16 a[8:11], v[176:179], v[136:139], a[8:11]
    ds_read_b64_tr_b16 v[104:105], v14 offset:49152
    v_mfma_f32_16x16x32_bf16 a[40:43], v[180:183], v[136:139], a[40:43]
    ds_read_b64_tr_b16 v[106:107], v14 offset:53248
    v_mfma_f32_16x16x32_bf16 a[12:15], v[176:179], v[140:143], a[12:15]
    ds_read_b64_tr_b16 v[108:109], v15 offset:49152
    v_mfma_f32_16x16x32_bf16 a[44:47], v[180:183], v[140:143], a[44:47]
    ds_read_b64_tr_b16 v[110:111], v15 offset:53248
    v_mfma_f32_16x16x32_bf16 a[16:19], v[176:179], v[144:147], a[16:19]
    ds_read_b64_tr_b16 v[112:113], v16 offset:49152
    v_mfma_f32_16x16x32_bf16 a[48:51], v[180:183], v[144:147], a[48:51]
    ds_read_b64_tr_b16 v[114:115], v16 offset:53248
    v_mfma_f32_16x16x32_bf16 a[20:23], v[176:179], v[148:151], a[20:23]
    ds_read_b64_tr_b16 v[116:117], v17 offset:49152
    v_mfma_f32_16x16x32_bf16 a[52:55], v[180:183], v[148:151], a[52:55]
    ds_read_b64_tr_b16 v[118:119], v17 offset:53248
    v_mfma_f32_16x16x32_bf16 a[24:27], v[176:179], v[152:155], a[24:27]
    ds_read_b64_tr_b16 v[120:121], v18 offset:49152
    v_mfma_f32_16x16x32_bf16 a[56:59], v[180:183], v[152:155], a[56:59]
    ds_read_b64_tr_b16 v[122:123], v18 offset:53248
    v_mfma_f32_16x16x32_bf16 a[28:31], v[176:179], v[156:159], a[28:31]
    ds_read_b64_tr_b16 v[124:125], v19 offset:49152
    v_mfma_f32_16x16x32_bf16 a[60:63], v[180:183], v[156:159], a[60:63]
    ds_read_b64_tr_b16 v[126:127], v19 offset:53248
    v_mfma_f32_16x16x32_bf16 a[64:67], v[160:163], v[128:131], a[64:67]
    v_mfma_f32_16x16x32_bf16 a[72:75], v[128:131], v[128:131], a[72:75]
    v_mfma_f32_16x16x32_bf16 a[68:71], v[160:163], v[132:135], a[68:71]
    v_mfma_f32_16x16x32_bf16 a[76:79], v[132:135], v[132:135], a[76:79]
    s_waitcnt lgkmcnt(0)
    v_mfma_f32_16x16x32_bf16 a[0:3], v[184:187], v[96:99], a[0:3]
    ds_read_b64_tr_b16 v[128:129], v12 offset:57344
    v_mfma_f32_16x16x32_bf16 a[32:35], v[188:191], v[96:99], a[32:35]
    ds_read_b64_tr_b16 v[130:131], v12 offset:61440
    v_mfma_f32_16x16x32_bf16 a[4:7], v[184:187], v[100:103], a[4:7]
    ds_read_b64_tr_b16 v[132:133], v13 offset:57344
    v_mfma_f32_16x16x32_bf16 a[36:39], v[188:191], v[100:103], a[36:39]
    ds_read_b64_tr_b16 v[134:135], v13 offset:61440
    v_mfma_f32_16x16x32_bf16 a[8:11], v[184:187], v[104:107], a[8:11]
    ds_read_b64_tr_b16 v[136:137], v14 offset:57344
    v_mfma_f32_16x16x32_bf16 a[40:43], v[188:191], v[104:107], a[40:43]
    ds_read_b64_tr_b16 v[138:139], v14 offset:61440
    v_mfma_f32_16x16x32_bf16 a[12:15], v[184:187], v[108:111], a[12:15]
    ds_read_b64_tr_b16 v[140:141], v15 offset:57344
    v_mfma_f32_16x16x32_bf16 a[44:47], v[188:191], v[108:111], a[44:47]
    ds_read_b64_tr_b16 v[142:143], v15 offset:61440
    v_mfma_f32_16x16x32_bf16 a[16:19], v[184:187], v[112:115], a[16:19]
    ds_read_b64_tr_b16 v[144:145], v16 offset:57344
    v_mfma_f32_16x16x32_bf16 a[48:51], v[188:191], v[112:115], a[48:51]
    ds_read_b64_tr_b16 v[146:147], v16 offset:61440
    v_mfma_f32_16x16x32_bf16 a[20:23], v[184:187], v[116:119], a[20:23]
    ds_read_b64_tr_b16 v[148:149], v17 offset:57344
    v_mfma_f32_16x16x32_bf16 a[52:55], v[188:191], v[116:119], a[52:55]
    ds_read_b64_tr_b16 v[150:151], v17 offset:61440
    v_mfma_f32_16x16x32_bf16 a[24:27], v[184:187], v[120:123], a[24:27]
    ds_read_b64_tr_b16 v[152:153], v18 offset:57344
    v_mfma_f32_16x16x32_bf16 a[56:59], v[188:191], v[120:123], a[56:59]
    ds_read_b64_tr_b16 v[154:155], v18 offset:61440
    v_mfma_f32_16x16x32_bf16 a[28:31], v[184:187], v[124:127], a[28:31]
    ds_read_b64_tr_b16 v[156:157], v19 offset:57344
    v_mfma_f32_16x16x32_bf16 a[60:63], v[188:191], v[124:127], a[60:63]
    ds_read_b64_tr_b16 v[158:159], v19 offset:61440
    v_mfma_f32_16x16x32_bf16 a[64:67], v[160:163], v[96:99], a[64:67]
    v_mfma_f32_16x16x32_bf16 a[72:75], v[96:99], v[96:99], a[72:75]
    v_mfma_f32_16x16x32_bf16 a[68:71], v[160:163], v[100:103], a[68:71]
    v_mfma_f32_16x16x32_bf16 a[76:79], v[100:103], v[100:103], a[76:79]
    s_waitcnt lgkmcnt(0)
    v_mfma_f32_16x16x32_bf16 a[64:67], v[160:163], v[128:131], a[64:67]
    v_mfma_f32_16x16x32_bf16 a[72:75], v[128:131], v[128:131], a[72:75]
    v_mfma_f32_16x16x32_bf16 a[68:71], v[160:163], v[132:135], a[68:71]
    v_mfma_f32_16x16x32_bf16 a[76:79], v[132:135], v[132:135], a[76:79]
    v_mfma_f32_16x16x32_bf16 a[0:3], v[192:195], v[128:131], a[0:3]
    v_mfma_f32_16x16x32_bf16 a[32:35], v[196:199], v[128:131], a[32:35]
    v_mfma_f32_16x16x32_bf16 a[4:7], v[192:195], v[132:135], a[4:7]
    v_mfma_f32_16x16x32_bf16 a[36:39], v[196:199], v[132:135], a[36:39]
    v_mfma_f32_16x16x32_bf16 a[8:11], v[192:195], v[136:139], a[8:11]
    v_mfma_f32_16x16x32_bf16 a[40:43], v[196:199], v[136:139], a[40:43]
    v_mfma_f32_16x16x32_bf16 a[12:15], v[192:195], v[140:143], a[12:15]
    v_mfma_f32_16x16x32_bf16 a[44:47], v[196:199], v[140:143], a[44:47]
    v_mfma_f32_16x16x32_bf16 a[16:19], v[192:195], v[144:147], a[16:19]
    v_mfma_f32_16x16x32_bf16 a[48:51], v[196:199], v[144:147], a[48:51]
    v_mfma_f32_16x16x32_bf16 a[20:23], v[192:195], v[148:151], a[20:23]
    v_mfma_f32_16x16x32_bf16 a[52:55], v[196:199], v[148:151], a[52:55]
    v_mfma_f32_16x16x32_bf16 a[24:27], v[192:195], v[152:155], a[24:27]
    v_mfma_f32_16x16x32_bf16 a[56:59], v[196:199], v[152:155], a[56:59]
    v_mfma_f32_16x16x32_bf16 a[28:31], v[192:195], v[156:159], a[28:31]
    v_mfma_f32_16x16x32_bf16 a[60:63], v[196:199], v[156:159], a[60:63]
    v_and_b32 v20, 3, v2
    v_accvgpr_read_b32 v164, a64
    v_accvgpr_read_b32 v165, a72
    v_accvgpr_read_b32 v21, a73
    v_cmp_eq_u32 vcc, 1, v20
    s_nop 1
    v_cndmask_b32 v165, v165, v21, vcc
    v_accvgpr_read_b32 v21, a74
    v_cmp_eq_u32 vcc, 2, v20
    s_nop 1
    v_cndmask_b32 v165, v165, v21, vcc
    v_accvgpr_read_b32 v21, a75
    v_cmp_eq_u32 vcc, 3, v20
    s_nop 1
    v_cndmask_b32 v165, v165, v21, vcc
    v_accvgpr_read_b32 v166, a68
    v_accvgpr_read_b32 v167, a76
    v_accvgpr_read_b32 v21, a77
    v_cmp_eq_u32 vcc, 1, v20
    s_nop 1
    v_cndmask_b32 v167, v167, v21, vcc
    v_accvgpr_read_b32 v21, a78
    v_cmp_eq_u32 vcc, 2, v20
    s_nop 1
    v_cndmask_b32 v167, v167, v21, vcc
    v_accvgpr_read_b32 v21, a79
    v_cmp_eq_u32 vcc, 3, v20
    s_nop 1
    v_cndmask_b32 v167, v167, v21, vcc
    v_mul_f32 v164, 0x3b000000, v164
    v_mul_f32 v165, 0x3b000000, v165
    v_mul_f32 v166, 0x3b000000, v166
    v_mul_f32 v167, 0x3b000000, v167
    v_fma_f32 v165, -v164, v164, v165
    v_fma_f32 v167, -v166, v166, v167
    v_max_f32 v165, 0, v165
    v_max_f32 v167, 0, v167
    v_cvt_pk_bf16_f32 v165, v165, v164
    v_cvt_pk_bf16_f32 v167, v167, v166
    v_and_b32 v176, 0xffff0000, v165
    v_lshlrev_b32 v165, 16, v165
    v_and_b32 v178, 0xffff0000, v167
    v_lshlrev_b32 v167, 16, v167
    v_add_f32 v165, 0x3727c5ac, v165
    v_add_f32 v167, 0x3727c5ac, v167
    v_cvt_pk_bf16_f32 v165, v165, v165
    v_cvt_pk_bf16_f32 v167, v167, v167
    v_lshlrev_b32 v165, 16, v165
    v_lshlrev_b32 v167, 16, v167
    v_sqrt_f32 v165, v165
    v_sqrt_f32 v167, v167
    s_nop 0
    v_cvt_pk_bf16_f32 v180, v165, v165
    v_cvt_pk_bf16_f32 v181, v167, v167
    v_lshlrev_b32 v180, 16, v180
    v_lshlrev_b32 v181, 16, v181
    v_rcp_f32 v177, v180
    v_rcp_f32 v179, v181
    s_nop 0
    v_mul_f32 v176, v176, v177
    v_mul_f32 v178, v178, v179
    v_lshlrev_b32 v20, 3, v2
    v_add_u32 v20, 0x20000, v20
    s_lshl_b32 s25, s3, 8
    v_add_u32 v21, s25, v20
    v_lshrrev_b32 v22, 2, v2
    v_cmp_eq_u32 vcc, v22, v3
    s_and_saveexec_b64 s[26:27], vcc
    ds_write_b64 v21, v[176:177] offset:0
    ds_write_b64 v21, v[178:179] offset:128
    s_mov_b64 exec, s[26:27]
    s_waitcnt lgkmcnt(0)
    s_barrier
    s_lshl_b32 s25, s3, 1
    s_add_u32 s25, s25, 0
    s_and_b32 s25, s25, 7
    s_lshl_b32 s32, s25, 7
    s_mul_i32 s40, s25, 57344
    v_add_u32 v21, s32, v20
    ds_read_b64 v[96:97], v21
    s_lshl_b32 s25, s3, 1
    s_add_u32 s25, s25, 1
    s_and_b32 s25, s25, 7
    s_lshl_b32 s33, s25, 7
    s_mul_i32 s41, s25, 57344
    v_add_u32 v21, s33, v20
    ds_read_b64 v[98:99], v21
    s_lshl_b32 s25, s3, 1
    s_add_u32 s25, s25, 2
    s_and_b32 s25, s25, 7
    s_lshl_b32 s34, s25, 7
    s_mul_i32 s42, s25, 57344
    v_add_u32 v21, s34, v20
    ds_read_b64 v[100:101], v21
    s_lshl_b32 s25, s3, 1
    s_add_u32 s25, s25, 3
    s_and_b32 s25, s25, 7
    s_lshl_b32 s35, s25, 7
    s_mul_i32 s43, s25, 57344
    v_add_u32 v21, s35, v20
    ds_read_b64 v[102:103], v21
    s_lshl_b32 s25, s3, 1
    s_add_u32 s25, s25, 4
    s_and_b32 s25, s25, 7
    s_lshl_b32 s36, s25, 7
    s_mul_i32 s44, s25, 57344
    v_add_u32 v21, s36, v20
    ds_read_b64 v[104:105], v21
    s_lshl_b32 s25, s3, 1
    s_add_u32 s25, s25, 5
    s_and_b32 s25, s25, 7
    s_lshl_b32 s37, s25, 7
    s_mul_i32 s45, s25, 57344
    v_add_u32 v21, s37, v20
    ds_read_b64 v[106:107], v21
    s_lshl_b32 s25, s3, 1
    s_add_u32 s25, s25, 6
    s_and_b32 s25, s25, 7
    s_lshl_b32 s38, s25, 7
    s_mul_i32 s46, s25, 57344
    v_add_u32 v21, s38, v20
    ds_read_b64 v[108:109], v21
    s_lshl_b32 s25, s3, 1
    s_add_u32 s25, s25, 7
    s_and_b32 s25, s25, 7
    s_lshl_b32 s39, s25, 7
    s_mul_i32 s47, s25, 57344
    v_add_u32 v21, s39, v20
    ds_read_b64 v[110:111], v21
    s_mul_i32 s25, s16, 448
    s_add_u32 s25, s25, s24
    s_lshl_b32 s25, s25, 10
    s_add_u32 s25, s25, 0x1000000
    s_add_u32 s40, s40, s25
    s_add_u32 s41, s41, s25
    s_add_u32 s42, s42, s25
    s_add_u32 s43, s43, s25
    s_add_u32 s44, s44, s25
    s_add_u32 s45, s45, s25
    s_add_u32 s46, s46, s25
    s_add_u32 s47, s47, s25
    s_waitcnt vmcnt(0) lgkmcnt(0)
    v_accvgpr_read_b32 v28, a0
    v_accvgpr_read_b32 v29, a1
    v_accvgpr_read_b32 v30, a2
    v_accvgpr_read_b32 v31, a3
    v_accvgpr_read_b32 v32, a32
    v_accvgpr_read_b32 v33, a33
    v_accvgpr_read_b32 v34, a34
    v_accvgpr_read_b32 v35, a35
    v_pk_mul_f32 v[28:29], v[28:29], v[96:97] op_sel:[0,1] op_sel_hi:[1,1]
    v_pk_mul_f32 v[30:31], v[30:31], v[96:97] op_sel:[0,1] op_sel_hi:[1,1]
    v_pk_mul_f32 v[32:33], v[32:33], v[96:97] op_sel:[0,1] op_sel_hi:[1,1]
    v_pk_mul_f32 v[34:35], v[34:35], v[96:97] op_sel:[0,1] op_sel_hi:[1,1]
    v_pk_fma_f32 v[28:29], v[240:241], v[96:97], v[28:29] op_sel_hi:[1,0,1] neg_lo:[0,1,0] neg_hi:[0,1,0]
    v_pk_fma_f32 v[30:31], v[242:243], v[96:97], v[30:31] op_sel_hi:[1,0,1] neg_lo:[0,1,0] neg_hi:[0,1,0]
    v_pk_fma_f32 v[32:33], v[244:245], v[96:97], v[32:33] op_sel_hi:[1,0,1] neg_lo:[0,1,0] neg_hi:[0,1,0]
    v_pk_fma_f32 v[34:35], v[246:247], v[96:97], v[34:35] op_sel_hi:[1,0,1] neg_lo:[0,1,0] neg_hi:[0,1,0]
    v_cvt_pk_bf16_f32 v128, v28, v29
    v_cvt_pk_bf16_f32 v129, v30, v31
    v_cvt_pk_bf16_f32 v130, v32, v33
    v_cvt_pk_bf16_f32 v131, v34, v35
    v_pk_max_i16 v128, v128, 0
    v_pk_max_i16 v129, v129, 0
    v_pk_max_i16 v130, v130, 0
    v_pk_max_i16 v131, v131, 0
    buffer_store_dwordx4 v[128:131], v9, s[4:7], s40 offen
    v_accvgpr_read_b32 v36, a4
    v_accvgpr_read_b32 v37, a5
    v_accvgpr_read_b32 v38, a6
    v_accvgpr_read_b32 v39, a7
    v_accvgpr_read_b32 v40, a36
    v_accvgpr_read_b32 v41, a37
    v_accvgpr_read_b32 v42, a38
    v_accvgpr_read_b32 v43, a39
    v_pk_mul_f32 v[36:37], v[36:37], v[98:99] op_sel:[0,1] op_sel_hi:[1,1]
    v_pk_mul_f32 v[38:39], v[38:39], v[98:99] op_sel:[0,1] op_sel_hi:[1,1]
    v_pk_mul_f32 v[40:41], v[40:41], v[98:99] op_sel:[0,1] op_sel_hi:[1,1]
    v_pk_mul_f32 v[42:43], v[42:43], v[98:99] op_sel:[0,1] op_sel_hi:[1,1]
    v_pk_fma_f32 v[36:37], v[240:241], v[98:99], v[36:37] op_sel_hi:[1,0,1] neg_lo:[0,1,0] neg_hi:[0,1,0]
    v_pk_fma_f32 v[38:39], v[242:243], v[98:99], v[38:39] op_sel_hi:[1,0,1] neg_lo:[0,1,0] neg_hi:[0,1,0]
    v_pk_fma_f32 v[40:41], v[244:245], v[98:99], v[40:41] op_sel_hi:[1,0,1] neg_lo:[0,1,0] neg_hi:[0,1,0]
    v_pk_fma_f32 v[42:43], v[246:247], v[98:99], v[42:43] op_sel_hi:[1,0,1] neg_lo:[0,1,0] neg_hi:[0,1,0]
    v_cvt_pk_bf16_f32 v132, v36, v37
    v_cvt_pk_bf16_f32 v133, v38, v39
    v_cvt_pk_bf16_f32 v134, v40, v41
    v_cvt_pk_bf16_f32 v135, v42, v43
    v_pk_max_i16 v132, v132, 0
    v_pk_max_i16 v133, v133, 0
    v_pk_max_i16 v134, v134, 0
    v_pk_max_i16 v135, v135, 0
    buffer_store_dwordx4 v[132:135], v9, s[4:7], s41 offen
    v_accvgpr_read_b32 v44, a8
    v_accvgpr_read_b32 v45, a9
    v_accvgpr_read_b32 v46, a10
    v_accvgpr_read_b32 v47, a11
    v_accvgpr_read_b32 v48, a40
    v_accvgpr_read_b32 v49, a41
    v_accvgpr_read_b32 v50, a42
    v_accvgpr_read_b32 v51, a43
    v_pk_mul_f32 v[44:45], v[44:45], v[100:101] op_sel:[0,1] op_sel_hi:[1,1]
    v_pk_mul_f32 v[46:47], v[46:47], v[100:101] op_sel:[0,1] op_sel_hi:[1,1]
    v_pk_mul_f32 v[48:49], v[48:49], v[100:101] op_sel:[0,1] op_sel_hi:[1,1]
    v_pk_mul_f32 v[50:51], v[50:51], v[100:101] op_sel:[0,1] op_sel_hi:[1,1]
    v_pk_fma_f32 v[44:45], v[240:241], v[100:101], v[44:45] op_sel_hi:[1,0,1] neg_lo:[0,1,0] neg_hi:[0,1,0]
    v_pk_fma_f32 v[46:47], v[242:243], v[100:101], v[46:47] op_sel_hi:[1,0,1] neg_lo:[0,1,0] neg_hi:[0,1,0]
    v_pk_fma_f32 v[48:49], v[244:245], v[100:101], v[48:49] op_sel_hi:[1,0,1] neg_lo:[0,1,0] neg_hi:[0,1,0]
    v_pk_fma_f32 v[50:51], v[246:247], v[100:101], v[50:51] op_sel_hi:[1,0,1] neg_lo:[0,1,0] neg_hi:[0,1,0]
    v_cvt_pk_bf16_f32 v136, v44, v45
    v_cvt_pk_bf16_f32 v137, v46, v47
    v_cvt_pk_bf16_f32 v138, v48, v49
    v_cvt_pk_bf16_f32 v139, v50, v51
    v_pk_max_i16 v136, v136, 0
    v_pk_max_i16 v137, v137, 0
    v_pk_max_i16 v138, v138, 0
    v_pk_max_i16 v139, v139, 0
    buffer_store_dwordx4 v[136:139], v9, s[4:7], s42 offen
    v_accvgpr_read_b32 v52, a12
    v_accvgpr_read_b32 v53, a13
    v_accvgpr_read_b32 v54, a14
    v_accvgpr_read_b32 v55, a15
    v_accvgpr_read_b32 v56, a44
    v_accvgpr_read_b32 v57, a45
    v_accvgpr_read_b32 v58, a46
    v_accvgpr_read_b32 v59, a47
    v_pk_mul_f32 v[52:53], v[52:53], v[102:103] op_sel:[0,1] op_sel_hi:[1,1]
    v_pk_mul_f32 v[54:55], v[54:55], v[102:103] op_sel:[0,1] op_sel_hi:[1,1]
    v_pk_mul_f32 v[56:57], v[56:57], v[102:103] op_sel:[0,1] op_sel_hi:[1,1]
    v_pk_mul_f32 v[58:59], v[58:59], v[102:103] op_sel:[0,1] op_sel_hi:[1,1]
    v_pk_fma_f32 v[52:53], v[240:241], v[102:103], v[52:53] op_sel_hi:[1,0,1] neg_lo:[0,1,0] neg_hi:[0,1,0]
    v_pk_fma_f32 v[54:55], v[242:243], v[102:103], v[54:55] op_sel_hi:[1,0,1] neg_lo:[0,1,0] neg_hi:[0,1,0]
    v_pk_fma_f32 v[56:57], v[244:245], v[102:103], v[56:57] op_sel_hi:[1,0,1] neg_lo:[0,1,0] neg_hi:[0,1,0]
    v_pk_fma_f32 v[58:59], v[246:247], v[102:103], v[58:59] op_sel_hi:[1,0,1] neg_lo:[0,1,0] neg_hi:[0,1,0]
    v_cvt_pk_bf16_f32 v140, v52, v53
    v_cvt_pk_bf16_f32 v141, v54, v55
    v_cvt_pk_bf16_f32 v142, v56, v57
    v_cvt_pk_bf16_f32 v143, v58, v59
    v_pk_max_i16 v140, v140, 0
    v_pk_max_i16 v141, v141, 0
    v_pk_max_i16 v142, v142, 0
    v_pk_max_i16 v143, v143, 0
    buffer_store_dwordx4 v[140:143], v9, s[4:7], s43 offen
    v_accvgpr_read_b32 v28, a16
    v_accvgpr_read_b32 v29, a17
    v_accvgpr_read_b32 v30, a18
    v_accvgpr_read_b32 v31, a19
    v_accvgpr_read_b32 v32, a48
    v_accvgpr_read_b32 v33, a49
    v_accvgpr_read_b32 v34, a50
    v_accvgpr_read_b32 v35, a51
    v_pk_mul_f32 v[28:29], v[28:29], v[104:105] op_sel:[0,1] op_sel_hi:[1,1]
    v_pk_mul_f32 v[30:31], v[30:31], v[104:105] op_sel:[0,1] op_sel_hi:[1,1]
    v_pk_mul_f32 v[32:33], v[32:33], v[104:105] op_sel:[0,1] op_sel_hi:[1,1]
    v_pk_mul_f32 v[34:35], v[34:35], v[104:105] op_sel:[0,1] op_sel_hi:[1,1]
    v_pk_fma_f32 v[28:29], v[240:241], v[104:105], v[28:29] op_sel_hi:[1,0,1] neg_lo:[0,1,0] neg_hi:[0,1,0]
    v_pk_fma_f32 v[30:31], v[242:243], v[104:105], v[30:31] op_sel_hi:[1,0,1] neg_lo:[0,1,0] neg_hi:[0,1,0]
    v_pk_fma_f32 v[32:33], v[244:245], v[104:105], v[32:33] op_sel_hi:[1,0,1] neg_lo:[0,1,0] neg_hi:[0,1,0]
    v_pk_fma_f32 v[34:35], v[246:247], v[104:105], v[34:35] op_sel_hi:[1,0,1] neg_lo:[0,1,0] neg_hi:[0,1,0]
    v_cvt_pk_bf16_f32 v128, v28, v29
    v_cvt_pk_bf16_f32 v129, v30, v31
    v_cvt_pk_bf16_f32 v130, v32, v33
    v_cvt_pk_bf16_f32 v131, v34, v35
    v_pk_max_i16 v128, v128, 0
    v_pk_max_i16 v129, v129, 0
    v_pk_max_i16 v130, v130, 0
    v_pk_max_i16 v131, v131, 0
    buffer_store_dwordx4 v[128:131], v9, s[4:7], s44 offen
    v_accvgpr_read_b32 v36, a20
    v_accvgpr_read_b32 v37, a21
    v_accvgpr_read_b32 v38, a22
    v_accvgpr_read_b32 v39, a23
    v_accvgpr_read_b32 v40, a52
    v_accvgpr_read_b32 v41, a53
    v_accvgpr_read_b32 v42, a54
    v_accvgpr_read_b32 v43, a55
    v_pk_mul_f32 v[36:37], v[36:37], v[106:107] op_sel:[0,1] op_sel_hi:[1,1]
    v_pk_mul_f32 v[38:39], v[38:39], v[106:107] op_sel:[0,1] op_sel_hi:[1,1]
    v_pk_mul_f32 v[40:41], v[40:41], v[106:107] op_sel:[0,1] op_sel_hi:[1,1]
    v_pk_mul_f32 v[42:43], v[42:43], v[106:107] op_sel:[0,1] op_sel_hi:[1,1]
    v_pk_fma_f32 v[36:37], v[240:241], v[106:107], v[36:37] op_sel_hi:[1,0,1] neg_lo:[0,1,0] neg_hi:[0,1,0]
    v_pk_fma_f32 v[38:39], v[242:243], v[106:107], v[38:39] op_sel_hi:[1,0,1] neg_lo:[0,1,0] neg_hi:[0,1,0]
    v_pk_fma_f32 v[40:41], v[244:245], v[106:107], v[40:41] op_sel_hi:[1,0,1] neg_lo:[0,1,0] neg_hi:[0,1,0]
    v_pk_fma_f32 v[42:43], v[246:247], v[106:107], v[42:43] op_sel_hi:[1,0,1] neg_lo:[0,1,0] neg_hi:[0,1,0]
    v_cvt_pk_bf16_f32 v132, v36, v37
    v_cvt_pk_bf16_f32 v133, v38, v39
    v_cvt_pk_bf16_f32 v134, v40, v41
    v_cvt_pk_bf16_f32 v135, v42, v43
    v_pk_max_i16 v132, v132, 0
    v_pk_max_i16 v133, v133, 0
    v_pk_max_i16 v134, v134, 0
    v_pk_max_i16 v135, v135, 0
    buffer_store_dwordx4 v[132:135], v9, s[4:7], s45 offen
    v_accvgpr_read_b32 v44, a24
    v_accvgpr_read_b32 v45, a25
    v_accvgpr_read_b32 v46, a26
    v_accvgpr_read_b32 v47, a27
    v_accvgpr_read_b32 v48, a56
    v_accvgpr_read_b32 v49, a57
    v_accvgpr_read_b32 v50, a58
    v_accvgpr_read_b32 v51, a59
    v_pk_mul_f32 v[44:45], v[44:45], v[108:109] op_sel:[0,1] op_sel_hi:[1,1]
    v_pk_mul_f32 v[46:47], v[46:47], v[108:109] op_sel:[0,1] op_sel_hi:[1,1]
    v_pk_mul_f32 v[48:49], v[48:49], v[108:109] op_sel:[0,1] op_sel_hi:[1,1]
    v_pk_mul_f32 v[50:51], v[50:51], v[108:109] op_sel:[0,1] op_sel_hi:[1,1]
    v_pk_fma_f32 v[44:45], v[240:241], v[108:109], v[44:45] op_sel_hi:[1,0,1] neg_lo:[0,1,0] neg_hi:[0,1,0]
    v_pk_fma_f32 v[46:47], v[242:243], v[108:109], v[46:47] op_sel_hi:[1,0,1] neg_lo:[0,1,0] neg_hi:[0,1,0]
    v_pk_fma_f32 v[48:49], v[244:245], v[108:109], v[48:49] op_sel_hi:[1,0,1] neg_lo:[0,1,0] neg_hi:[0,1,0]
    v_pk_fma_f32 v[50:51], v[246:247], v[108:109], v[50:51] op_sel_hi:[1,0,1] neg_lo:[0,1,0] neg_hi:[0,1,0]
    v_cvt_pk_bf16_f32 v136, v44, v45
    v_cvt_pk_bf16_f32 v137, v46, v47
    v_cvt_pk_bf16_f32 v138, v48, v49
    v_cvt_pk_bf16_f32 v139, v50, v51
    v_pk_max_i16 v136, v136, 0
    v_pk_max_i16 v137, v137, 0
    v_pk_max_i16 v138, v138, 0
    v_pk_max_i16 v139, v139, 0
    buffer_store_dwordx4 v[136:139], v9, s[4:7], s46 offen
    v_accvgpr_read_b32 v52, a28
    v_accvgpr_read_b32 v53, a29
    v_accvgpr_read_b32 v54, a30
    v_accvgpr_read_b32 v55, a31
    v_accvgpr_read_b32 v56, a60
    v_accvgpr_read_b32 v57, a61
    v_accvgpr_read_b32 v58, a62
    v_accvgpr_read_b32 v59, a63
    v_pk_mul_f32 v[52:53], v[52:53], v[110:111] op_sel:[0,1] op_sel_hi:[1,1]
    v_pk_mul_f32 v[54:55], v[54:55], v[110:111] op_sel:[0,1] op_sel_hi:[1,1]
    v_pk_mul_f32 v[56:57], v[56:57], v[110:111] op_sel:[0,1] op_sel_hi:[1,1]
    v_pk_mul_f32 v[58:59], v[58:59], v[110:111] op_sel:[0,1] op_sel_hi:[1,1]
    v_pk_fma_f32 v[52:53], v[240:241], v[110:111], v[52:53] op_sel_hi:[1,0,1] neg_lo:[0,1,0] neg_hi:[0,1,0]
    v_pk_fma_f32 v[54:55], v[242:243], v[110:111], v[54:55] op_sel_hi:[1,0,1] neg_lo:[0,1,0] neg_hi:[0,1,0]
    v_pk_fma_f32 v[56:57], v[244:245], v[110:111], v[56:57] op_sel_hi:[1,0,1] neg_lo:[0,1,0] neg_hi:[0,1,0]
    v_pk_fma_f32 v[58:59], v[246:247], v[110:111], v[58:59] op_sel_hi:[1,0,1] neg_lo:[0,1,0] neg_hi:[0,1,0]
    v_cvt_pk_bf16_f32 v140, v52, v53
    v_cvt_pk_bf16_f32 v141, v54, v55
    v_cvt_pk_bf16_f32 v142, v56, v57
    v_cvt_pk_bf16_f32 v143, v58, v59
    v_pk_max_i16 v140, v140, 0
    v_pk_max_i16 v141, v141, 0
    v_pk_max_i16 v142, v142, 0
    v_pk_max_i16 v143, v143, 0
    buffer_store_dwordx4 v[140:143], v9, s[4:7], s47 offen
L_g1_kernel_end:
    s_endpgm

.globl g2_kernel
.p2align 8
.type g2_kernel,@function
g2_kernel:

    s_cmp_ge_u32 s2, 256
    s_cbranch_scc1 L_g2_kernel_end
    s_load_dwordx2 s[12:13], s[0:1], 96
    s_load_dwordx2 s[14:15], s[0:1], 80
    v_and_b32 v1, 63, v0
    v_lshrrev_b32 v4, 6, v0
    v_and_b32 v2, 15, v0
    v_bfe_u32 v3, v0, 4, 2
    v_readfirstlane_b32 s3, v4
    s_and_b32 s16, s2, 7
    s_lshl_b32 s16, s16, 2
    s_bfe_u32 s17, s2, 0x20003
    s_add_u32 s16, s16, s17
    s_lshr_b32 s17, s2, 5
    v_lshlrev_b32 v5, 4, v1
    v_add_u32 v6, 57344, v5
    v_add_u32 v7, 114688, v5
    v_add_u32 v8, 172032, v5
    s_mul_i32 s18, s16, 224
    s_mul_i32 s19, s3, 14
    s_add_u32 s18, s18, s19
    s_lshl_b32 s18, s18, 10
    s_add_u32 s18, s18, 0x1000000
    s_mul_i32 s20, s17, 56
    s_add_u32 s20, s20, s19
    s_lshl_b32 s20, s20, 12
    s_add_u32 s20, s20, 0xe00000
    v_mul_u32_u24 v9, 4352, v1
    s_mul_i32 s21, s17, 278528
    s_lshl_b32 s22, s16, 7
    s_add_u32 s21, s21, s22
    s_lshl_b32 s22, s3, 5
    s_add_u32 s21, s21, s22
    s_add_u32 s22, s21, 0x240000
    s_mov_b32 s31, 0x90c004
    s_waitcnt lgkmcnt(0)
    s_mov_b32 s4, s12
    s_and_b32 s5, s13, 0xffff
    s_mov_b32 s6, 0x2000000
    s_mov_b32 s7, 0x00020000
    buffer_load_dwordx4 v[24:27], v5, s[4:7], s18 offen
    buffer_load_dwordx4 v[40:43], v5, s[4:7], s20 offen offset:0
    buffer_load_dwordx4 v[28:31], v6, s[4:7], s18 offen
    buffer_load_dwordx4 v[44:47], v5, s[4:7], s20 offen offset:1024
    buffer_load_dwordx4 v[32:35], v7, s[4:7], s18 offen
    buffer_load_dwordx4 v[48:51], v5, s[4:7], s20 offen offset:2048
    buffer_load_dwordx4 v[36:39], v8, s[4:7], s18 offen
    buffer_load_dwordx4 v[52:55], v5, s[4:7], s20 offen offset:3072
    s_add_u32 s18, s18, 1024
    s_add_u32 s20, s20, 4096
    buffer_load_dwordx4 v[56:59], v5, s[4:7], s18 offen
    buffer_load_dwordx4 v[72:75], v5, s[4:7], s20 offen offset:0
    buffer_load_dwordx4 v[60:63], v6, s[4:7], s18 offen
    buffer_load_dwordx4 v[76:79], v5, s[4:7], s20 offen offset:1024
    buffer_load_dwordx4 v[64:67], v7, s[4:7], s18 offen
    buffer_load_dwordx4 v[80:83], v5, s[4:7], s20 offen offset:2048
    buffer_load_dwordx4 v[68:71], v8, s[4:7], s18 offen
    buffer_load_dwordx4 v[84:87], v5, s[4:7], s20 offen offset:3072
    s_add_u32 s18, s18, 1024
    s_add_u32 s20, s20, 4096
    buffer_load_dwordx4 v[88:91], v5, s[4:7], s18 offen
    buffer_load_dwordx4 v[104:107], v5, s[4:7], s20 offen offset:0
    buffer_load_dwordx4 v[92:95], v6, s[4:7], s18 offen
    buffer_load_dwordx4 v[108:111], v5, s[4:7], s20 offen offset:1024
    buffer_load_dwordx4 v[96:99], v7, s[4:7], s18 offen
    buffer_load_dwordx4 v[112:115], v5, s[4:7], s20 offen offset:2048
    buffer_load_dwordx4 v[100:103], v8, s[4:7], s18 offen
    buffer_load_dwordx4 v[116:119], v5, s[4:7], s20 offen offset:3072
    s_add_u32 s18, s18, 1024
    s_add_u32 s20, s20, 4096
    buffer_load_dwordx4 v[12:15], v9, s[4:7], s22 offen
    buffer_load_dwordx4 v[16:19], v9, s[4:7], s22 offen offset:16
    s_buffer_load_dword s30, s[4:7], s31
    s_mov_b32 s8, s14
    s_and_b32 s9, s15, 0xffff
    s_mov_b32 s10, 0x200000
    s_mov_b32 s11, 0x00020000
    v_mul_u32_u24 v10, 272, v2
    v_lshl_add_u32 v10, v3, 4, v10
    s_mul_i32 s23, s3, 17408
    s_add_u32 s23, s23, 9216
    v_add_u32 v10, s23, v10
    v_mul_u32_u24 v11, 272, v1
    s_lshl_b32 s23, s3, 6
    v_add_u32 v11, s23, v11
    s_waitcnt vmcnt(18)
    v_mfma_f32_16x16x32_bf16 a[0:3], v[24:27], v[40:43], 0
    buffer_load_dwordx4 v[120:123], v5, s[4:7], s18 offen
    v_mfma_f32_16x16x32_bf16 a[4:7], v[24:27], v[44:47], 0
    buffer_load_dwordx4 v[136:139], v5, s[4:7], s20 offen offset:0
    v_mfma_f32_16x16x32_bf16 a[8:11], v[24:27], v[48:51], 0
    buffer_load_dwordx4 v[124:127], v6, s[4:7], s18 offen
    v_mfma_f32_16x16x32_bf16 a[12:15], v[24:27], v[52:55], 0
    buffer_load_dwordx4 v[140:143], v5, s[4:7], s20 offen offset:1024
    v_mfma_f32_16x16x32_bf16 a[16:19], v[28:31], v[40:43], 0
    buffer_load_dwordx4 v[128:131], v7, s[4:7], s18 offen
    v_mfma_f32_16x16x32_bf16 a[20:23], v[28:31], v[44:47], 0
    buffer_load_dwordx4 v[144:147], v5, s[4:7], s20 offen offset:2048
    v_mfma_f32_16x16x32_bf16 a[24:27], v[28:31], v[48:51], 0
    buffer_load_dwordx4 v[132:135], v8, s[4:7], s18 offen
    v_mfma_f32_16x16x32_bf16 a[28:31], v[28:31], v[52:55], 0
    buffer_load_dwordx4 v[148:151], v5, s[4:7], s20 offen offset:3072
    s_add_u32 s18, s18, 1024
    s_add_u32 s20, s20, 4096
    v_mfma_f32_16x16x32_bf16 a[32:35], v[32:35], v[40:43], 0
    buffer_load_dwordx4 v[152:155], v5, s[4:7], s18 offen
    v_mfma_f32_16x16x32_bf16 a[36:39], v[32:35], v[44:47], 0
    buffer_load_dwordx4 v[168:171], v5, s[4:7], s20 offen offset:0
    v_mfma_f32_16x16x32_bf16 a[40:43], v[32:35], v[48:51], 0
    buffer_load_dwordx4 v[156:159], v6, s[4:7], s18 offen
    v_mfma_f32_16x16x32_bf16 a[44:47], v[32:35], v[52:55], 0
    buffer_load_dwordx4 v[172:175], v5, s[4:7], s20 offen offset:1024
    v_mfma_f32_16x16x32_bf16 a[48:51], v[36:39], v[40:43], 0
    buffer_load_dwordx4 v[160:163], v7, s[4:7], s18 offen
    v_mfma_f32_16x16x32_bf16 a[52:55], v[36:39], v[44:47], 0
    buffer_load_dwordx4 v[176:179], v5, s[4:7], s20 offen offset:2048
    v_mfma_f32_16x16x32_bf16 a[56:59], v[36:39], v[48:51], 0
    buffer_load_dwordx4 v[164:167], v8, s[4:7], s18 offen
    v_mfma_f32_16x16x32_bf16 a[60:63], v[36:39], v[52:55], 0
    buffer_load_dwordx4 v[180:183], v5, s[4:7], s20 offen offset:3072
    s_add_u32 s18, s18, 1024
    s_add_u32 s20, s20, 4096
    s_waitcnt vmcnt(26)
    v_mfma_f32_16x16x32_bf16 a[0:3], v[56:59], v[72:75], a[0:3]
    buffer_load_dwordx4 v[184:187], v5, s[4:7], s18 offen
    v_mfma_f32_16x16x32_bf16 a[4:7], v[56:59], v[76:79], a[4:7]
    buffer_load_dwordx4 v[200:203], v5, s[4:7], s20 offen offset:0
    v_mfma_f32_16x16x32_bf16 a[8:11], v[56:59], v[80:83], a[8:11]
    buffer_load_dwordx4 v[188:191], v6, s[4:7], s18 offen
    v_mfma_f32_16x16x32_bf16 a[12:15], v[56:59], v[84:87], a[12:15]
    buffer_load_dwordx4 v[204:207], v5, s[4:7], s20 offen offset:1024
    v_mfma_f32_16x16x32_bf16 a[16:19], v[60:63], v[72:75], a[16:19]
    buffer_load_dwordx4 v[192:195], v7, s[4:7], s18 offen
    v_mfma_f32_16x16x32_bf16 a[20:23], v[60:63], v[76:79], a[20:23]
    buffer_load_dwordx4 v[208:211], v5, s[4:7], s20 offen offset:2048
    v_mfma_f32_16x16x32_bf16 a[24:27], v[60:63], v[80:83], a[24:27]
    buffer_load_dwordx4 v[196:199], v8, s[4:7], s18 offen
    v_mfma_f32_16x16x32_bf16 a[28:31], v[60:63], v[84:87], a[28:31]
    buffer_load_dwordx4 v[212:215], v5, s[4:7], s20 offen offset:3072
    s_add_u32 s18, s18, 1024
    s_add_u32 s20, s20, 4096
    v_mfma_f32_16x16x32_bf16 a[32:35], v[64:67], v[72:75], a[32:35]
    buffer_load_dwordx4 v[216:219], v5, s[4:7], s18 offen
    v_mfma_f32_16x16x32_bf16 a[36:39], v[64:67], v[76:79], a[36:39]
    buffer_load_dwordx4 v[232:235], v5, s[4:7], s20 offen offset:0
    v_mfma_f32_16x16x32_bf16 a[40:43], v[64:67], v[80:83], a[40:43]
    buffer_load_dwordx4 v[220:223], v6, s[4:7], s18 offen
    v_mfma_f32_16x16x32_bf16 a[44:47], v[64:67], v[84:87], a[44:47]
    buffer_load_dwordx4 v[236:239], v5, s[4:7], s20 offen offset:1024
    v_mfma_f32_16x16x32_bf16 a[48:51], v[68:71], v[72:75], a[48:51]
    buffer_load_dwordx4 v[224:227], v7, s[4:7], s18 offen
    v_mfma_f32_16x16x32_bf16 a[52:55], v[68:71], v[76:79], a[52:55]
    buffer_load_dwordx4 v[240:243], v5, s[4:7], s20 offen offset:2048
    v_mfma_f32_16x16x32_bf16 a[56:59], v[68:71], v[80:83], a[56:59]
    buffer_load_dwordx4 v[228:231], v8, s[4:7], s18 offen
    v_mfma_f32_16x16x32_bf16 a[60:63], v[68:71], v[84:87], a[60:63]
    buffer_load_dwordx4 v[244:247], v5, s[4:7], s20 offen offset:3072
    s_add_u32 s18, s18, 1024
    s_add_u32 s20, s20, 4096
    s_waitcnt vmcnt(34)
    v_mfma_f32_16x16x32_bf16 a[0:3], v[88:91], v[104:107], a[0:3]
    buffer_load_dwordx4 v[24:27], v5, s[4:7], s18 offen
    v_mfma_f32_16x16x32_bf16 a[4:7], v[88:91], v[108:111], a[4:7]
    buffer_load_dwordx4 v[40:43], v5, s[4:7], s20 offen offset:0
    v_mfma_f32_16x16x32_bf16 a[8:11], v[88:91], v[112:115], a[8:11]
    buffer_load_dwordx4 v[28:31], v6, s[4:7], s18 offen
    v_mfma_f32_16x16x32_bf16 a[12:15], v[88:91], v[116:119], a[12:15]
    buffer_load_dwordx4 v[44:47], v5, s[4:7], s20 offen offset:1024
    v_mfma_f32_16x16x32_bf16 a[16:19], v[92:95], v[104:107], a[16:19]
    buffer_load_dwordx4 v[32:35], v7, s[4:7], s18 offen
    v_mfma_f32_16x16x32_bf16 a[20:23], v[92:95], v[108:111], a[20:23]
    buffer_load_dwordx4 v[48:51], v5, s[4:7], s20 offen offset:2048
    v_mfma_f32_16x16x32_bf16 a[24:27], v[92:95], v[112:115], a[24:27]
    buffer_load_dwordx4 v[36:39], v8, s[4:7], s18 offen
    v_mfma_f32_16x16x32_bf16 a[28:31], v[92:95], v[116:119], a[28:31]
    buffer_load_dwordx4 v[52:55], v5, s[4:7], s20 offen offset:3072
    s_add_u32 s18, s18, 1024
    s_add_u32 s20, s20, 4096
    v_mfma_f32_16x16x32_bf16 a[32:35], v[96:99], v[104:107], a[32:35]
    buffer_load_dwordx4 v[56:59], v5, s[4:7], s18 offen
    v_mfma_f32_16x16x32_bf16 a[36:39], v[96:99], v[108:111], a[36:39]
    buffer_load_dwordx4 v[72:75], v5, s[4:7], s20 offen offset:0
    v_mfma_f32_16x16x32_bf16 a[40:43], v[96:99], v[112:115], a[40:43]
    buffer_load_dwordx4 v[60:63], v6, s[4:7], s18 offen
    v_mfma_f32_16x16x32_bf16 a[44:47], v[96:99], v[116:119], a[44:47]
    buffer_load_dwordx4 v[76:79], v5, s[4:7], s20 offen offset:1024
    v_mfma_f32_16x16x32_bf16 a[48:51], v[100:103], v[104:107], a[48:51]
    buffer_load_dwordx4 v[64:67], v7, s[4:7], s18 offen
    v_mfma_f32_16x16x32_bf16 a[52:55], v[100:103], v[108:111], a[52:55]
    buffer_load_dwordx4 v[80:83], v5, s[4:7], s20 offen offset:2048
    v_mfma_f32_16x16x32_bf16 a[56:59], v[100:103], v[112:115], a[56:59]
    buffer_load_dwordx4 v[68:71], v8, s[4:7], s18 offen
    v_mfma_f32_16x16x32_bf16 a[60:63], v[100:103], v[116:119], a[60:63]
    buffer_load_dwordx4 v[84:87], v5, s[4:7], s20 offen offset:3072
    s_add_u32 s18, s18, 1024
    s_add_u32 s20, s20, 4096
    s_waitcnt vmcnt(40)
    v_mfma_f32_16x16x32_bf16 a[0:3], v[120:123], v[136:139], a[0:3]
    v_mfma_f32_16x16x32_bf16 a[4:7], v[120:123], v[140:143], a[4:7]
    buffer_load_dwordx4 v[88:91], v5, s[4:7], s18 offen
    v_mfma_f32_16x16x32_bf16 a[8:11], v[120:123], v[144:147], a[8:11]
    v_mfma_f32_16x16x32_bf16 a[12:15], v[120:123], v[148:151], a[12:15]
    buffer_load_dwordx4 v[104:107], v5, s[4:7], s20 offen offset:0
    v_mfma_f32_16x16x32_bf16 a[16:19], v[124:127], v[136:139], a[16:19]
    v_mfma_f32_16x16x32_bf16 a[20:23], v[124:127], v[140:143], a[20:23]
    buffer_load_dwordx4 v[92:95], v6, s[4:7], s18 offen
    v_mfma_f32_16x16x32_bf16 a[24:27], v[124:127], v[144:147], a[24:27]
    v_mfma_f32_16x16x32_bf16 a[28:31], v[124:127], v[148:151], a[28:31]
    buffer_load_dwordx4 v[108:111], v5, s[4:7], s20 offen offset:1024
    v_mfma_f32_16x16x32_bf16 a[32:35], v[128:131], v[136:139], a[32:35]
    v_mfma_f32_16x16x32_bf16 a[36:39], v[128:131], v[140:143], a[36:39]
    buffer_load_dwordx4 v[96:99], v7, s[4:7], s18 offen
    v_mfma_f32_16x16x32_bf16 a[40:43], v[128:131], v[144:147], a[40:43]
    v_mfma_f32_16x16x32_bf16 a[44:47], v[128:131], v[148:151], a[44:47]
    buffer_load_dwordx4 v[112:115], v5, s[4:7], s20 offen offset:2048
    v_mfma_f32_16x16x32_bf16 a[48:51], v[132:135], v[136:139], a[48:51]
    v_mfma_f32_16x16x32_bf16 a[52:55], v[132:135], v[140:143], a[52:55]
    buffer_load_dwordx4 v[100:103], v8, s[4:7], s18 offen
    v_mfma_f32_16x16x32_bf16 a[56:59], v[132:135], v[144:147], a[56:59]
    v_mfma_f32_16x16x32_bf16 a[60:63], v[132:135], v[148:151], a[60:63]
    buffer_load_dwordx4 v[116:119], v5, s[4:7], s20 offen offset:3072
    s_add_u32 s18, s18, 1024
    s_add_u32 s20, s20, 4096
    s_waitcnt vmcnt(40)
    v_mfma_f32_16x16x32_bf16 a[0:3], v[152:155], v[168:171], a[0:3]
    v_mfma_f32_16x16x32_bf16 a[4:7], v[152:155], v[172:175], a[4:7]
    buffer_load_dwordx4 v[120:123], v5, s[4:7], s18 offen
    v_mfma_f32_16x16x32_bf16 a[8:11], v[152:155], v[176:179], a[8:11]
    v_mfma_f32_16x16x32_bf16 a[12:15], v[152:155], v[180:183], a[12:15]
    buffer_load_dwordx4 v[136:139], v5, s[4:7], s20 offen offset:0
    v_mfma_f32_16x16x32_bf16 a[16:19], v[156:159], v[168:171], a[16:19]
    v_mfma_f32_16x16x32_bf16 a[20:23], v[156:159], v[172:175], a[20:23]
    buffer_load_dwordx4 v[124:127], v6, s[4:7], s18 offen
    v_mfma_f32_16x16x32_bf16 a[24:27], v[156:159], v[176:179], a[24:27]
    v_mfma_f32_16x16x32_bf16 a[28:31], v[156:159], v[180:183], a[28:31]
    buffer_load_dwordx4 v[140:143], v5, s[4:7], s20 offen offset:1024
    v_mfma_f32_16x16x32_bf16 a[32:35], v[160:163], v[168:171], a[32:35]
    v_mfma_f32_16x16x32_bf16 a[36:39], v[160:163], v[172:175], a[36:39]
    buffer_load_dwordx4 v[128:131], v7, s[4:7], s18 offen
    v_mfma_f32_16x16x32_bf16 a[40:43], v[160:163], v[176:179], a[40:43]
    v_mfma_f32_16x16x32_bf16 a[44:47], v[160:163], v[180:183], a[44:47]
    buffer_load_dwordx4 v[144:147], v5, s[4:7], s20 offen offset:2048
    v_mfma_f32_16x16x32_bf16 a[48:51], v[164:167], v[168:171], a[48:51]
    v_mfma_f32_16x16x32_bf16 a[52:55], v[164:167], v[172:175], a[52:55]
    buffer_load_dwordx4 v[132:135], v8, s[4:7], s18 offen
    v_mfma_f32_16x16x32_bf16 a[56:59], v[164:167], v[176:179], a[56:59]
    v_mfma_f32_16x16x32_bf16 a[60:63], v[164:167], v[180:183], a[60:63]
    buffer_load_dwordx4 v[148:151], v5, s[4:7], s20 offen offset:3072
    s_add_u32 s18, s18, 1024
    s_add_u32 s20, s20, 4096
    s_waitcnt vmcnt(40)
    v_mfma_f32_16x16x32_bf16 a[0:3], v[184:187], v[200:203], a[0:3]
    v_mfma_f32_16x16x32_bf16 a[4:7], v[184:187], v[204:207], a[4:7]
    buffer_load_dwordx4 v[152:155], v5, s[4:7], s18 offen
    v_mfma_f32_16x16x32_bf16 a[8:11], v[184:187], v[208:211], a[8:11]
    v_mfma_f32_16x16x32_bf16 a[12:15], v[184:187], v[212:215], a[12:15]
    buffer_load_dwordx4 v[168:171], v5, s[4:7], s20 offen offset:0
    v_mfma_f32_16x16x32_bf16 a[16:19], v[188:191], v[200:203], a[16:19]
    v_mfma_f32_16x16x32_bf16 a[20:23], v[188:191], v[204:207], a[20:23]
    buffer_load_dwordx4 v[156:159], v6, s[4:7], s18 offen
    v_mfma_f32_16x16x32_bf16 a[24:27], v[188:191], v[208:211], a[24:27]
    v_mfma_f32_16x16x32_bf16 a[28:31], v[188:191], v[212:215], a[28:31]
    buffer_load_dwordx4 v[172:175], v5, s[4:7], s20 offen offset:1024
    v_mfma_f32_16x16x32_bf16 a[32:35], v[192:195], v[200:203], a[32:35]
    v_mfma_f32_16x16x32_bf16 a[36:39], v[192:195], v[204:207], a[36:39]
    buffer_load_dwordx4 v[160:163], v7, s[4:7], s18 offen
    v_mfma_f32_16x16x32_bf16 a[40:43], v[192:195], v[208:211], a[40:43]
    v_mfma_f32_16x16x32_bf16 a[44:47], v[192:195], v[212:215], a[44:47]
    buffer_load_dwordx4 v[176:179], v5, s[4:7], s20 offen offset:2048
    v_mfma_f32_16x16x32_bf16 a[48:51], v[196:199], v[200:203], a[48:51]
    v_mfma_f32_16x16x32_bf16 a[52:55], v[196:199], v[204:207], a[52:55]
    buffer_load_dwordx4 v[164:167], v8, s[4:7], s18 offen
    v_mfma_f32_16x16x32_bf16 a[56:59], v[196:199], v[208:211], a[56:59]
    v_mfma_f32_16x16x32_bf16 a[60:63], v[196:199], v[212:215], a[60:63]
    buffer_load_dwordx4 v[180:183], v5, s[4:7], s20 offen offset:3072
    s_add_u32 s18, s18, 1024
    s_add_u32 s20, s20, 4096
    s_waitcnt vmcnt(40)
    v_mfma_f32_16x16x32_bf16 a[0:3], v[216:219], v[232:235], a[0:3]
    v_mfma_f32_16x16x32_bf16 a[4:7], v[216:219], v[236:239], a[4:7]
    buffer_load_dwordx4 v[184:187], v5, s[4:7], s18 offen
    v_mfma_f32_16x16x32_bf16 a[8:11], v[216:219], v[240:243], a[8:11]
    v_mfma_f32_16x16x32_bf16 a[12:15], v[216:219], v[244:247], a[12:15]
    buffer_load_dwordx4 v[200:203], v5, s[4:7], s20 offen offset:0
    v_mfma_f32_16x16x32_bf16 a[16:19], v[220:223], v[232:235], a[16:19]
    v_mfma_f32_16x16x32_bf16 a[20:23], v[220:223], v[236:239], a[20:23]
    buffer_load_dwordx4 v[188:191], v6, s[4:7], s18 offen
    v_mfma_f32_16x16x32_bf16 a[24:27], v[220:223], v[240:243], a[24:27]
    v_mfma_f32_16x16x32_bf16 a[28:31], v[220:223], v[244:247], a[28:31]
    buffer_load_dwordx4 v[204:207], v5, s[4:7], s20 offen offset:1024
    v_mfma_f32_16x16x32_bf16 a[32:35], v[224:227], v[232:235], a[32:35]
    v_mfma_f32_16x16x32_bf16 a[36:39], v[224:227], v[236:239], a[36:39]
    buffer_load_dwordx4 v[192:195], v7, s[4:7], s18 offen
    v_mfma_f32_16x16x32_bf16 a[40:43], v[224:227], v[240:243], a[40:43]
    v_mfma_f32_16x16x32_bf16 a[44:47], v[224:227], v[244:247], a[44:47]
    buffer_load_dwordx4 v[208:211], v5, s[4:7], s20 offen offset:2048
    v_mfma_f32_16x16x32_bf16 a[48:51], v[228:231], v[232:235], a[48:51]
    v_mfma_f32_16x16x32_bf16 a[52:55], v[228:231], v[236:239], a[52:55]
    buffer_load_dwordx4 v[196:199], v8, s[4:7], s18 offen
    v_mfma_f32_16x16x32_bf16 a[56:59], v[228:231], v[240:243], a[56:59]
    v_mfma_f32_16x16x32_bf16 a[60:63], v[228:231], v[244:247], a[60:63]
    buffer_load_dwordx4 v[212:215], v5, s[4:7], s20 offen offset:3072
    s_add_u32 s18, s18, 1024
    s_add_u32 s20, s20, 4096
    s_waitcnt vmcnt(40)
    v_mfma_f32_16x16x32_bf16 a[0:3], v[24:27], v[40:43], a[0:3]
    v_mfma_f32_16x16x32_bf16 a[4:7], v[24:27], v[44:47], a[4:7]
    buffer_load_dwordx4 v[216:219], v5, s[4:7], s18 offen
    v_mfma_f32_16x16x32_bf16 a[8:11], v[24:27], v[48:51], a[8:11]
    v_mfma_f32_16x16x32_bf16 a[12:15], v[24:27], v[52:55], a[12:15]
    buffer_load_dwordx4 v[232:235], v5, s[4:7], s20 offen offset:0
    v_mfma_f32_16x16x32_bf16 a[16:19], v[28:31], v[40:43], a[16:19]
    v_mfma_f32_16x16x32_bf16 a[20:23], v[28:31], v[44:47], a[20:23]
    buffer_load_dwordx4 v[220:223], v6, s[4:7], s18 offen
    v_mfma_f32_16x16x32_bf16 a[24:27], v[28:31], v[48:51], a[24:27]
    v_mfma_f32_16x16x32_bf16 a[28:31], v[28:31], v[52:55], a[28:31]
    buffer_load_dwordx4 v[236:239], v5, s[4:7], s20 offen offset:1024
    v_mfma_f32_16x16x32_bf16 a[32:35], v[32:35], v[40:43], a[32:35]
    v_mfma_f32_16x16x32_bf16 a[36:39], v[32:35], v[44:47], a[36:39]
    buffer_load_dwordx4 v[224:227], v7, s[4:7], s18 offen
    v_mfma_f32_16x16x32_bf16 a[40:43], v[32:35], v[48:51], a[40:43]
    v_mfma_f32_16x16x32_bf16 a[44:47], v[32:35], v[52:55], a[44:47]
    buffer_load_dwordx4 v[240:243], v5, s[4:7], s20 offen offset:2048
    v_mfma_f32_16x16x32_bf16 a[48:51], v[36:39], v[40:43], a[48:51]
    v_mfma_f32_16x16x32_bf16 a[52:55], v[36:39], v[44:47], a[52:55]
    buffer_load_dwordx4 v[228:231], v8, s[4:7], s18 offen
    v_mfma_f32_16x16x32_bf16 a[56:59], v[36:39], v[48:51], a[56:59]
    v_mfma_f32_16x16x32_bf16 a[60:63], v[36:39], v[52:55], a[60:63]
    buffer_load_dwordx4 v[244:247], v5, s[4:7], s20 offen offset:3072
    s_add_u32 s18, s18, 1024
    s_add_u32 s20, s20, 4096
    s_waitcnt vmcnt(40)
    v_mfma_f32_16x16x32_bf16 a[0:3], v[56:59], v[72:75], a[0:3]
    v_mfma_f32_16x16x32_bf16 a[4:7], v[56:59], v[76:79], a[4:7]
    v_mfma_f32_16x16x32_bf16 a[8:11], v[56:59], v[80:83], a[8:11]
    v_mfma_f32_16x16x32_bf16 a[12:15], v[56:59], v[84:87], a[12:15]
    v_mfma_f32_16x16x32_bf16 a[16:19], v[60:63], v[72:75], a[16:19]
    v_mfma_f32_16x16x32_bf16 a[20:23], v[60:63], v[76:79], a[20:23]
    v_mfma_f32_16x16x32_bf16 a[24:27], v[60:63], v[80:83], a[24:27]
    v_mfma_f32_16x16x32_bf16 a[28:31], v[60:63], v[84:87], a[28:31]
    v_mfma_f32_16x16x32_bf16 a[32:35], v[64:67], v[72:75], a[32:35]
    v_mfma_f32_16x16x32_bf16 a[36:39], v[64:67], v[76:79], a[36:39]
    v_mfma_f32_16x16x32_bf16 a[40:43], v[64:67], v[80:83], a[40:43]
    v_mfma_f32_16x16x32_bf16 a[44:47], v[64:67], v[84:87], a[44:47]
    v_mfma_f32_16x16x32_bf16 a[48:51], v[68:71], v[72:75], a[48:51]
    v_mfma_f32_16x16x32_bf16 a[52:55], v[68:71], v[76:79], a[52:55]
    v_mfma_f32_16x16x32_bf16 a[56:59], v[68:71], v[80:83], a[56:59]
    v_mfma_f32_16x16x32_bf16 a[60:63], v[68:71], v[84:87], a[60:63]
    s_waitcnt vmcnt(32)
    v_mfma_f32_16x16x32_bf16 a[0:3], v[88:91], v[104:107], a[0:3]
    v_mfma_f32_16x16x32_bf16 a[4:7], v[88:91], v[108:111], a[4:7]
    v_mfma_f32_16x16x32_bf16 a[8:11], v[88:91], v[112:115], a[8:11]
    v_mfma_f32_16x16x32_bf16 a[12:15], v[88:91], v[116:119], a[12:15]
    v_mfma_f32_16x16x32_bf16 a[16:19], v[92:95], v[104:107], a[16:19]
    v_mfma_f32_16x16x32_bf16 a[20:23], v[92:95], v[108:111], a[20:23]
    v_mfma_f32_16x16x32_bf16 a[24:27], v[92:95], v[112:115], a[24:27]
    v_mfma_f32_16x16x32_bf16 a[28:31], v[92:95], v[116:119], a[28:31]
    v_mfma_f32_16x16x32_bf16 a[32:35], v[96:99], v[104:107], a[32:35]
    v_mfma_f32_16x16x32_bf16 a[36:39], v[96:99], v[108:111], a[36:39]
    v_mfma_f32_16x16x32_bf16 a[40:43], v[96:99], v[112:115], a[40:43]
    v_mfma_f32_16x16x32_bf16 a[44:47], v[96:99], v[116:119], a[44:47]
    v_mfma_f32_16x16x32_bf16 a[48:51], v[100:103], v[104:107], a[48:51]
    v_mfma_f32_16x16x32_bf16 a[52:55], v[100:103], v[108:111], a[52:55]
    v_mfma_f32_16x16x32_bf16 a[56:59], v[100:103], v[112:115], a[56:59]
    v_mfma_f32_16x16x32_bf16 a[60:63], v[100:103], v[116:119], a[60:63]
    s_waitcnt vmcnt(24)
    v_mfma_f32_16x16x32_bf16 a[0:3], v[120:123], v[136:139], a[0:3]
    v_mfma_f32_16x16x32_bf16 a[4:7], v[120:123], v[140:143], a[4:7]
    v_mfma_f32_16x16x32_bf16 a[8:11], v[120:123], v[144:147], a[8:11]
    v_mfma_f32_16x16x32_bf16 a[12:15], v[120:123], v[148:151], a[12:15]
    v_mfma_f32_16x16x32_bf16 a[16:19], v[124:127], v[136:139], a[16:19]
    v_mfma_f32_16x16x32_bf16 a[20:23], v[124:127], v[140:143], a[20:23]
    v_mfma_f32_16x16x32_bf16 a[24:27], v[124:127], v[144:147], a[24:27]
    v_mfma_f32_16x16x32_bf16 a[28:31], v[124:127], v[148:151], a[28:31]
    v_mfma_f32_16x16x32_bf16 a[32:35], v[128:131], v[136:139], a[32:35]
    v_mfma_f32_16x16x32_bf16 a[36:39], v[128:131], v[140:143], a[36:39]
    v_mfma_f32_16x16x32_bf16 a[40:43], v[128:131], v[144:147], a[40:43]
    v_mfma_f32_16x16x32_bf16 a[44:47], v[128:131], v[148:151], a[44:47]
    v_mfma_f32_16x16x32_bf16 a[48:51], v[132:135], v[136:139], a[48:51]
    v_mfma_f32_16x16x32_bf16 a[52:55], v[132:135], v[140:143], a[52:55]
    v_mfma_f32_16x16x32_bf16 a[56:59], v[132:135], v[144:147], a[56:59]
    v_mfma_f32_16x16x32_bf16 a[60:63], v[132:135], v[148:151], a[60:63]
    s_waitcnt vmcnt(16)
    v_mfma_f32_16x16x32_bf16 a[0:3], v[152:155], v[168:171], a[0:3]
    v_mfma_f32_16x16x32_bf16 a[4:7], v[152:155], v[172:175], a[4:7]
    v_mfma_f32_16x16x32_bf16 a[8:11], v[152:155], v[176:179], a[8:11]
    v_mfma_f32_16x16x32_bf16 a[12:15], v[152:155], v[180:183], a[12:15]
    v_mfma_f32_16x16x32_bf16 a[16:19], v[156:159], v[168:171], a[16:19]
    v_mfma_f32_16x16x32_bf16 a[20:23], v[156:159], v[172:175], a[20:23]
    v_mfma_f32_16x16x32_bf16 a[24:27], v[156:159], v[176:179], a[24:27]
    v_mfma_f32_16x16x32_bf16 a[28:31], v[156:159], v[180:183], a[28:31]
    v_mfma_f32_16x16x32_bf16 a[32:35], v[160:163], v[168:171], a[32:35]
    v_mfma_f32_16x16x32_bf16 a[36:39], v[160:163], v[172:175], a[36:39]
    v_mfma_f32_16x16x32_bf16 a[40:43], v[160:163], v[176:179], a[40:43]
    v_mfma_f32_16x16x32_bf16 a[44:47], v[160:163], v[180:183], a[44:47]
    v_mfma_f32_16x16x32_bf16 a[48:51], v[164:167], v[168:171], a[48:51]
    v_mfma_f32_16x16x32_bf16 a[52:55], v[164:167], v[172:175], a[52:55]
    v_mfma_f32_16x16x32_bf16 a[56:59], v[164:167], v[176:179], a[56:59]
    v_mfma_f32_16x16x32_bf16 a[60:63], v[164:167], v[180:183], a[60:63]
    s_waitcnt vmcnt(8)
    v_mfma_f32_16x16x32_bf16 a[0:3], v[184:187], v[200:203], a[0:3]
    v_mfma_f32_16x16x32_bf16 a[4:7], v[184:187], v[204:207], a[4:7]
    v_mfma_f32_16x16x32_bf16 a[8:11], v[184:187], v[208:211], a[8:11]
    v_mfma_f32_16x16x32_bf16 a[12:15], v[184:187], v[212:215], a[12:15]
    v_mfma_f32_16x16x32_bf16 a[16:19], v[188:191], v[200:203], a[16:19]
    v_mfma_f32_16x16x32_bf16 a[20:23], v[188:191], v[204:207], a[20:23]
    v_mfma_f32_16x16x32_bf16 a[24:27], v[188:191], v[208:211], a[24:27]
    v_mfma_f32_16x16x32_bf16 a[28:31], v[188:191], v[212:215], a[28:31]
    v_mfma_f32_16x16x32_bf16 a[32:35], v[192:195], v[200:203], a[32:35]
    v_mfma_f32_16x16x32_bf16 a[36:39], v[192:195], v[204:207], a[36:39]
    v_mfma_f32_16x16x32_bf16 a[40:43], v[192:195], v[208:211], a[40:43]
    v_mfma_f32_16x16x32_bf16 a[44:47], v[192:195], v[212:215], a[44:47]
    v_mfma_f32_16x16x32_bf16 a[48:51], v[196:199], v[200:203], a[48:51]
    v_mfma_f32_16x16x32_bf16 a[52:55], v[196:199], v[204:207], a[52:55]
    v_mfma_f32_16x16x32_bf16 a[56:59], v[196:199], v[208:211], a[56:59]
    v_mfma_f32_16x16x32_bf16 a[60:63], v[196:199], v[212:215], a[60:63]
    s_waitcnt vmcnt(0)
    v_mfma_f32_16x16x32_bf16 a[0:3], v[216:219], v[232:235], a[0:3]
    v_mfma_f32_16x16x32_bf16 a[4:7], v[216:219], v[236:239], a[4:7]
    v_mfma_f32_16x16x32_bf16 a[8:11], v[216:219], v[240:243], a[8:11]
    v_mfma_f32_16x16x32_bf16 a[12:15], v[216:219], v[244:247], a[12:15]
    v_mfma_f32_16x16x32_bf16 a[16:19], v[220:223], v[232:235], a[16:19]
    v_mfma_f32_16x16x32_bf16 a[20:23], v[220:223], v[236:239], a[20:23]
    v_mfma_f32_16x16x32_bf16 a[24:27], v[220:223], v[240:243], a[24:27]
    v_mfma_f32_16x16x32_bf16 a[28:31], v[220:223], v[244:247], a[28:31]
    v_mfma_f32_16x16x32_bf16 a[32:35], v[224:227], v[232:235], a[32:35]
    ds_write_b128 v10, a[0:3] offset:0
    v_mfma_f32_16x16x32_bf16 a[36:39], v[224:227], v[236:239], a[36:39]
    ds_write_b128 v10, a[4:7] offset:4352
    v_mfma_f32_16x16x32_bf16 a[40:43], v[224:227], v[240:243], a[40:43]
    ds_write_b128 v10, a[8:11] offset:8704
    v_mfma_f32_16x16x32_bf16 a[44:47], v[224:227], v[244:247], a[44:47]
    ds_write_b128 v10, a[12:15] offset:13056
    v_mfma_f32_16x16x32_bf16 a[48:51], v[228:231], v[232:235], a[48:51]
    ds_write_b128 v10, a[16:19] offset:64
    v_mfma_f32_16x16x32_bf16 a[52:55], v[228:231], v[236:239], a[52:55]
    ds_write_b128 v10, a[20:23] offset:4416
    v_mfma_f32_16x16x32_bf16 a[56:59], v[228:231], v[240:243], a[56:59]
    ds_write_b128 v10, a[24:27] offset:8768
    v_mfma_f32_16x16x32_bf16 a[60:63], v[228:231], v[244:247], a[60:63]
    ds_write_b128 v10, a[28:31] offset:13120
    s_nop 3
    ds_write_b128 v10, a[32:35] offset:128
    ds_write_b128 v10, a[36:39] offset:4480
    ds_write_b128 v10, a[40:43] offset:8832
    ds_write_b128 v10, a[44:47] offset:13184
    s_nop 3
    ds_write_b128 v10, a[48:51] offset:192
    ds_write_b128 v10, a[52:55] offset:4544
    ds_write_b128 v10, a[56:59] offset:8896
    ds_write_b128 v10, a[60:63] offset:13248
    s_waitcnt lgkmcnt(0)
    s_barrier
    ds_read_b128 v[32:35], v11 offset:9216
    ds_read_b128 v[36:39], v11 offset:9232
    ds_read_b128 v[40:43], v11 offset:9248
    ds_read_b128 v[44:47], v11 offset:9264
    ds_read_b128 v[48:51], v11 offset:26624
    ds_read_b128 v[52:55], v11 offset:26640
    ds_read_b128 v[56:59], v11 offset:26656
    ds_read_b128 v[60:63], v11 offset:26672
    ds_read_b128 v[64:67], v11 offset:44032
    ds_read_b128 v[68:71], v11 offset:44048
    ds_read_b128 v[72:75], v11 offset:44064
    ds_read_b128 v[76:79], v11 offset:44080
    ds_read_b128 v[80:83], v11 offset:61440
    ds_read_b128 v[84:87], v11 offset:61456
    ds_read_b128 v[88:91], v11 offset:61472
    ds_read_b128 v[92:95], v11 offset:61488
    v_lshlrev_b32 v96, 16, v12
    v_and_b32 v97, 0xffff0000, v12
    v_lshlrev_b32 v98, 16, v13
    v_and_b32 v99, 0xffff0000, v13
    v_lshlrev_b32 v100, 16, v14
    v_and_b32 v101, 0xffff0000, v14
    v_lshlrev_b32 v102, 16, v15
    v_and_b32 v103, 0xffff0000, v15
    v_lshlrev_b32 v104, 16, v16
    v_and_b32 v105, 0xffff0000, v16
    v_lshlrev_b32 v106, 16, v17
    v_and_b32 v107, 0xffff0000, v17
    v_lshlrev_b32 v108, 16, v18
    v_and_b32 v109, 0xffff0000, v18
    v_lshlrev_b32 v110, 16, v19
    v_and_b32 v111, 0xffff0000, v19
    s_waitcnt lgkmcnt(8)
    v_pk_add_f32 v[32:33], v[32:33], v[48:49]
    v_pk_add_f32 v[34:35], v[34:35], v[50:51]
    v_pk_add_f32 v[36:37], v[36:37], v[52:53]
    v_pk_add_f32 v[38:39], v[38:39], v[54:55]
    v_pk_add_f32 v[40:41], v[40:41], v[56:57]
    v_pk_add_f32 v[42:43], v[42:43], v[58:59]
    v_pk_add_f32 v[44:45], v[44:45], v[60:61]
    v_pk_add_f32 v[46:47], v[46:47], v[62:63]
    s_waitcnt lgkmcnt(0)
    v_pk_add_f32 v[64:65], v[64:65], v[80:81]
    v_pk_add_f32 v[66:67], v[66:67], v[82:83]
    v_pk_add_f32 v[68:69], v[68:69], v[84:85]
    v_pk_add_f32 v[70:71], v[70:71], v[86:87]
    v_pk_add_f32 v[72:73], v[72:73], v[88:89]
    v_pk_add_f32 v[74:75], v[74:75], v[90:91]
    v_pk_add_f32 v[76:77], v[76:77], v[92:93]
    v_pk_add_f32 v[78:79], v[78:79], v[94:95]
    v_pk_add_f32 v[32:33], v[32:33], v[64:65]
    v_pk_add_f32 v[34:35], v[34:35], v[66:67]
    v_pk_add_f32 v[36:37], v[36:37], v[68:69]
    v_pk_add_f32 v[38:39], v[38:39], v[70:71]
    v_pk_add_f32 v[40:41], v[40:41], v[72:73]
    v_pk_add_f32 v[42:43], v[42:43], v[74:75]
    v_pk_add_f32 v[44:45], v[44:45], v[76:77]
    v_pk_add_f32 v[46:47], v[46:47], v[78:79]
    v_cvt_pk_bf16_f32 v48, v32, v33
    v_cvt_pk_bf16_f32 v49, v34, v35
    v_cvt_pk_bf16_f32 v50, v36, v37
    v_cvt_pk_bf16_f32 v51, v38, v39
    v_cvt_pk_bf16_f32 v52, v40, v41
    v_cvt_pk_bf16_f32 v53, v42, v43
    v_cvt_pk_bf16_f32 v54, v44, v45
    v_cvt_pk_bf16_f32 v55, v46, v47
    v_lshlrev_b32 v32, 16, v48
    v_and_b32 v33, 0xffff0000, v48
    v_lshlrev_b32 v34, 16, v49
    v_and_b32 v35, 0xffff0000, v49
    v_lshlrev_b32 v36, 16, v50
    v_and_b32 v37, 0xffff0000, v50
    v_lshlrev_b32 v38, 16, v51
    v_and_b32 v39, 0xffff0000, v51
    v_lshlrev_b32 v40, 16, v52
    v_and_b32 v41, 0xffff0000, v52
    v_lshlrev_b32 v42, 16, v53
    v_and_b32 v43, 0xffff0000, v53
    v_lshlrev_b32 v44, 16, v54
    v_and_b32 v45, 0xffff0000, v54
    v_lshlrev_b32 v46, 16, v55
    v_and_b32 v47, 0xffff0000, v55
    v_pk_add_f32 v[32:33], v[32:33], v[96:97]
    v_pk_add_f32 v[34:35], v[34:35], v[98:99]
    v_pk_add_f32 v[36:37], v[36:37], v[100:101]
    v_pk_add_f32 v[38:39], v[38:39], v[102:103]
    v_pk_add_f32 v[40:41], v[40:41], v[104:105]
    v_pk_add_f32 v[42:43], v[42:43], v[106:107]
    v_pk_add_f32 v[44:45], v[44:45], v[108:109]
    v_pk_add_f32 v[46:47], v[46:47], v[110:111]
    v_cvt_pk_bf16_f32 v64, v32, v33
    v_cvt_pk_bf16_f32 v65, v34, v35
    v_cvt_pk_bf16_f32 v66, v36, v37
    v_cvt_pk_bf16_f32 v67, v38, v39
    v_cvt_pk_bf16_f32 v68, v40, v41
    v_cvt_pk_bf16_f32 v69, v42, v43
    v_cvt_pk_bf16_f32 v70, v44, v45
    v_cvt_pk_bf16_f32 v71, v46, v47
    s_cmp_lg_u32 s30, 0
    s_cbranch_scc1 L_g2_kernel_final
    s_add_u32 s22, s21, 0x0
    buffer_store_dwordx4 v[64:67], v9, s[4:7], s22 offen sc1
    buffer_store_dwordx4 v[68:71], v9, s[4:7], s22 offen offset:16 sc1
    v_lshlrev_b32 v32, 16, v64
    v_and_b32 v33, 0xffff0000, v64
    v_lshlrev_b32 v34, 16, v65
    v_and_b32 v35, 0xffff0000, v65
    v_lshlrev_b32 v36, 16, v66
    v_and_b32 v37, 0xffff0000, v66
    v_lshlrev_b32 v38, 16, v67
    v_and_b32 v39, 0xffff0000, v67
    v_lshlrev_b32 v40, 16, v68
    v_and_b32 v41, 0xffff0000, v68
    v_lshlrev_b32 v42, 16, v69
    v_and_b32 v43, 0xffff0000, v69
    v_lshlrev_b32 v44, 16, v70
    v_and_b32 v45, 0xffff0000, v70
    v_lshlrev_b32 v46, 16, v71
    v_and_b32 v47, 0xffff0000, v71
    v_pk_mul_f32 v[48:49], v[32:33], v[32:33]
    v_pk_mul_f32 v[50:51], v[34:35], v[34:35]
    v_pk_mul_f32 v[52:53], v[36:37], v[36:37]
    v_pk_mul_f32 v[54:55], v[38:39], v[38:39]
    v_pk_mul_f32 v[56:57], v[40:41], v[40:41]
    v_pk_mul_f32 v[58:59], v[42:43], v[42:43]
    v_pk_mul_f32 v[60:61], v[44:45], v[44:45]
    v_pk_mul_f32 v[62:63], v[46:47], v[46:47]
    s_nop 1
    v_permlane32_swap_b32 v32, v48
    v_permlane32_swap_b32 v33, v49
    v_permlane32_swap_b32 v34, v50
    v_permlane32_swap_b32 v35, v51
    v_permlane32_swap_b32 v36, v52
    v_permlane32_swap_b32 v37, v53
    v_permlane32_swap_b32 v38, v54
    v_permlane32_swap_b32 v39, v55
    v_permlane32_swap_b32 v40, v56
    v_permlane32_swap_b32 v41, v57
    v_permlane32_swap_b32 v42, v58
    v_permlane32_swap_b32 v43, v59
    v_permlane32_swap_b32 v44, v60
    v_permlane32_swap_b32 v45, v61
    v_permlane32_swap_b32 v46, v62
    v_permlane32_swap_b32 v47, v63
    v_pk_add_f32 v[32:33], v[32:33], v[48:49]
    v_pk_add_f32 v[34:35], v[34:35], v[50:51]
    v_pk_add_f32 v[36:37], v[36:37], v[52:53]
    v_pk_add_f32 v[38:39], v[38:39], v[54:55]
    v_pk_add_f32 v[40:41], v[40:41], v[56:57]
    v_pk_add_f32 v[42:43], v[42:43], v[58:59]
    v_pk_add_f32 v[44:45], v[44:45], v[60:61]
    v_pk_add_f32 v[46:47], v[46:47], v[62:63]
    s_nop 1
    v_permlane16_swap_b32 v32, v40
    v_permlane16_swap_b32 v33, v41
    v_permlane16_swap_b32 v34, v42
    v_permlane16_swap_b32 v35, v43
    v_permlane16_swap_b32 v36, v44
    v_permlane16_swap_b32 v37, v45
    v_permlane16_swap_b32 v38, v46
    v_permlane16_swap_b32 v39, v47
    v_pk_add_f32 v[32:33], v[32:33], v[40:41]
    v_pk_add_f32 v[34:35], v[34:35], v[42:43]
    v_pk_add_f32 v[36:37], v[36:37], v[44:45]
    v_pk_add_f32 v[38:39], v[38:39], v[46:47]
    s_nop 0
    v_add_f32_dpp v32, v32, v32 row_ror:8 row_mask:0xf bank_mask:0xf
    v_add_f32_dpp v33, v33, v33 row_ror:8 row_mask:0xf bank_mask:0xf
    v_add_f32_dpp v34, v34, v34 row_ror:8 row_mask:0xf bank_mask:0xf
    v_add_f32_dpp v35, v35, v35 row_ror:8 row_mask:0xf bank_mask:0xf
    v_add_f32_dpp v36, v36, v36 row_ror:8 row_mask:0xf bank_mask:0xf
    v_add_f32_dpp v37, v37, v37 row_ror:8 row_mask:0xf bank_mask:0xf
    v_add_f32_dpp v38, v38, v38 row_ror:8 row_mask:0xf bank_mask:0xf
    v_add_f32_dpp v39, v39, v39 row_ror:8 row_mask:0xf bank_mask:0xf
    s_nop 0
    v_add_f32_dpp v32, v32, v32 row_ror:4 row_mask:0xf bank_mask:0xf
    v_add_f32_dpp v33, v33, v33 row_ror:4 row_mask:0xf bank_mask:0xf
    v_add_f32_dpp v34, v34, v34 row_ror:4 row_mask:0xf bank_mask:0xf
    v_add_f32_dpp v35, v35, v35 row_ror:4 row_mask:0xf bank_mask:0xf
    v_add_f32_dpp v36, v36, v36 row_ror:4 row_mask:0xf bank_mask:0xf
    v_add_f32_dpp v37, v37, v37 row_ror:4 row_mask:0xf bank_mask:0xf
    v_add_f32_dpp v38, v38, v38 row_ror:4 row_mask:0xf bank_mask:0xf
    v_add_f32_dpp v39, v39, v39 row_ror:4 row_mask:0xf bank_mask:0xf
    s_nop 0
    v_add_f32_dpp v32, v32, v32 row_ror:2 row_mask:0xf bank_mask:0xf
    v_add_f32_dpp v33, v33, v33 row_ror:2 row_mask:0xf bank_mask:0xf
    v_add_f32_dpp v34, v34, v34 row_ror:2 row_mask:0xf bank_mask:0xf
    v_add_f32_dpp v35, v35, v35 row_ror:2 row_mask:0xf bank_mask:0xf
    v_add_f32_dpp v36, v36, v36 row_ror:2 row_mask:0xf bank_mask:0xf
    v_add_f32_dpp v37, v37, v37 row_ror:2 row_mask:0xf bank_mask:0xf
    v_add_f32_dpp v38, v38, v38 row_ror:2 row_mask:0xf bank_mask:0xf
    v_add_f32_dpp v39, v39, v39 row_ror:2 row_mask:0xf bank_mask:0xf
    s_nop 0
    v_add_f32_dpp v32, v32, v32 row_ror:1 row_mask:0xf bank_mask:0xf
    v_add_f32_dpp v33, v33, v33 row_ror:1 row_mask:0xf bank_mask:0xf
    v_add_f32_dpp v34, v34, v34 row_ror:1 row_mask:0xf bank_mask:0xf
    v_add_f32_dpp v35, v35, v35 row_ror:1 row_mask:0xf bank_mask:0xf
    v_add_f32_dpp v36, v36, v36 row_ror:1 row_mask:0xf bank_mask:0xf
    v_add_f32_dpp v37, v37, v37 row_ror:1 row_mask:0xf bank_mask:0xf
    v_add_f32_dpp v38, v38, v38 row_ror:1 row_mask:0xf bank_mask:0xf
    v_add_f32_dpp v39, v39, v39 row_ror:1 row_mask:0xf bank_mask:0xf
    v_cmp_eq_u32 vcc, 1, v2
    s_nop 1
    v_cndmask_b32 v32, v32, v33, vcc
    v_cmp_eq_u32 vcc, 2, v2
    s_nop 1
    v_cndmask_b32 v32, v32, v34, vcc
    v_cmp_eq_u32 vcc, 3, v2
    s_nop 1
    v_cndmask_b32 v32, v32, v35, vcc
    v_cmp_eq_u32 vcc, 4, v2
    s_nop 1
    v_cndmask_b32 v32, v32, v36, vcc
    v_cmp_eq_u32 vcc, 5, v2
    s_nop 1
    v_cndmask_b32 v32, v32, v37, vcc
    v_cmp_eq_u32 vcc, 6, v2
    s_nop 1
    v_cndmask_b32 v32, v32, v38, vcc
    v_cmp_eq_u32 vcc, 7, v2
    s_nop 1
    v_cndmask_b32 v32, v32, v39, vcc
    v_and_b32 v13, 1, v3
    v_lshl_add_u32 v13, v13, 3, v2
    v_lshlrev_b32 v13, 3, v13
    v_lshrrev_b32 v14, 1, v3
    v_lshl_add_u32 v13, v14, 2, v13
    s_lshl_b32 s22, s16, 9
    s_lshl_b32 s23, s3, 7
    s_add_u32 s22, s22, s23
    s_add_u32 s22, s22, 0x900000
    v_cmp_gt_u32 vcc, 8, v2
    s_and_saveexec_b64 s[26:27], vcc
    buffer_atomic_add_f32 v32, v13, s[4:7], s22 offen
    s_endpgm
L_g2_kernel_final:
    v_mul_u32_u24 v12, 144, v1
    s_lshl_b32 s23, s3, 5
    v_add_u32 v12, s23, v12
    ds_write_b128 v12, v[64:67] offset:0
    ds_write_b128 v12, v[68:71] offset:16
    v_lshrrev_b32 v13, 2, v2
    v_lshl_add_u32 v13, v3, 3, v13
    v_mul_u32_u24 v13, 144, v13
    v_and_b32 v14, 3, v2
    v_lshl_add_u32 v13, v14, 3, v13
    v_add_u32 v13, s23, v13
    s_waitcnt lgkmcnt(0)
    ds_read_b64_tr_b16 v[72:73], v13 offset:0
    ds_read_b64_tr_b16 v[74:75], v13 offset:576
    ds_read_b64_tr_b16 v[76:77], v13 offset:4608
    ds_read_b64_tr_b16 v[78:79], v13 offset:5184
    s_lshl_b32 s23, s3, 4
    v_add_u32 v14, s23, v2
    v_lshlrev_b32 v14, 10, v14
    v_lshl_add_u32 v14, v3, 4, v14
    s_lshl_b32 s22, s16, 16
    s_lshl_b32 s23, s17, 7
    s_add_u32 s22, s22, s23
    s_waitcnt lgkmcnt(0)
    buffer_store_dwordx4 v[72:75], v14, s[8:11], s22 offen sc1
    buffer_store_dwordx4 v[76:79], v14, s[8:11], s22 offen offset:64 sc1
L_g2_kernel_end:
    s_endpgm

.section .rodata,"a"
.p2align 6
.amdhsa_kernel prep_kernel
  .amdhsa_next_free_vgpr 124
  .amdhsa_next_free_sgpr 96
  .amdhsa_accum_offset 112
  .amdhsa_group_segment_fixed_size 0
  .amdhsa_kernarg_size 104
  .amdhsa_user_sgpr_count 2
  .amdhsa_user_sgpr_kernarg_segment_ptr 1
  .amdhsa_system_sgpr_workgroup_id_x 1
  .amdhsa_float_denorm_mode_32 3
.end_amdhsa_kernel

.p2align 6
.amdhsa_kernel conv_kernel
  .amdhsa_next_free_vgpr 256
  .amdhsa_next_free_sgpr 96
  .amdhsa_accum_offset 224
  .amdhsa_group_segment_fixed_size 0
  .amdhsa_kernarg_size 104
  .amdhsa_user_sgpr_count 2
  .amdhsa_user_sgpr_kernarg_segment_ptr 1
  .amdhsa_system_sgpr_workgroup_id_x 1
  .amdhsa_float_denorm_mode_32 3
.end_amdhsa_kernel

.p2align 6
.amdhsa_kernel g1_kernel
  .amdhsa_next_free_vgpr 328
  .amdhsa_next_free_sgpr 96
  .amdhsa_accum_offset 248
  .amdhsa_group_segment_fixed_size 0
  .amdhsa_kernarg_size 104
  .amdhsa_user_sgpr_count 2
  .amdhsa_user_sgpr_kernarg_segment_ptr 1
  .amdhsa_system_sgpr_workgroup_id_x 1
  .amdhsa_float_denorm_mode_32 3
.end_amdhsa_kernel

.p2align 6
.amdhsa_kernel g2_kernel
  .amdhsa_next_free_vgpr 312
  .amdhsa_next_free_sgpr 96
  .amdhsa_accum_offset 248
  .amdhsa_group_segment_fixed_size 0
  .amdhsa_kernarg_size 104
  .amdhsa_user_sgpr_count 2
  .amdhsa_user_sgpr_kernarg_segment_ptr 1
  .amdhsa_system_sgpr_workgroup_id_x 1
  .amdhsa_float_denorm_mode_32 3
.end_amdhsa_kernel
```
